```python
import torch

def _softmax(x, axis=-1):
    return torch.softmax(x, dim=axis)
def _gelu(x):
    return torch.nn.functional.gelu(x, approximate="tanh")
def _silu(x):
    return torch.nn.functional.silu(x)
def _sigmoid(x):
    return torch.sigmoid(x)
def _layernorm(x, axis=-1, eps=1e-5):
    m = x.mean(dim=axis, keepdim=True)
    v = x.var(dim=axis, keepdim=True, unbiased=False)
    return (x - m) / torch.sqrt(v + eps)
def _scatter_add(tgt, idx, src, axis=0):
    return tgt.clone().index_add_(axis, idx, src)
def _segment_sum(src, seg, n):
    out = torch.zeros((n,) + src.shape[1:], dtype=src.dtype)
    return out.index_add_(0, seg, src)
def _pad(x, pw):
    flat = tuple(v for pair in reversed(pw) for v in pair)
    return torch.nn.functional.pad(x, flat)

kernel_name = 'standalone__gqa_softmax__near_ridge'

def setup_inputs():

    _w = (lambda a: (lambda t: t.to(torch.bfloat16) if t.is_floating_point() else t)(torch.as_tensor(a)))
    B, Hq, Hkv, Sq, Sk, D = 32, 16, 8, 256, 256, 256
    return {
        "q": _w((lambda *s: torch.randn(*s, dtype=torch.bfloat16) * 0.8)(B, Hq, Sq, D)),
        "k": _w((lambda *s: torch.randn(*s, dtype=torch.bfloat16) * 0.8)(B, Hkv, Sk, D)),
        "v": _w((lambda *s: torch.randn(*s, dtype=torch.bfloat16) * 0.05)(B, Hkv, Sk, D)),
    }

def reference(q, k, v):
    B, Hq, Sq, D = q.shape
    Hkv = k.shape[1]
    rep = Hq // Hkv
    k = (lambda x, n, axis: torch.repeat_interleave(x, n, dim=axis))(k, rep, axis=1)
    v = (lambda x, n, axis: torch.repeat_interleave(x, n, dim=axis))(v, rep, axis=1)
    scale = D ** -0.5
    scores = torch.einsum("bhqd,bhkd->bhqk", q, k) * scale
    p = _softmax(scores, axis=-1)
    return torch.einsum("bhqk,bhkd->bhqd", p, v)
```

```asm
; @launch grid=(256,1,1) block=(512,1,1) lds=152576
.amdgcn_target "amdgcn-amd-amdhsa--gfx950"
.text
.globl standalone__gqa_softmax__near_ridge_kernel
.p2align 8
.type standalone__gqa_softmax__near_ridge_kernel,@function
standalone__gqa_softmax__near_ridge_kernel:
    s_cmp_ge_u32 s2, 256
    s_cbranch_scc1 L_end
    s_and_b32 s3, s2, 7
    s_lshl_b32 s3, s3, 5
    s_lshr_b32 s2, s2, 3
    s_add_u32 s2, s2, s3
    s_load_dwordx4 s[20:23], s[0:1], 0
    s_load_dwordx4 s[24:27], s[0:1], 16
    v_and_b32 v255, 63, v0
    v_lshrrev_b32 v130, 6, v0
    s_nop 0
    v_readfirstlane_b32 s28, v130
    v_and_b32 v128, 31, v255
    v_lshrrev_b32 v129, 5, v255
    s_nop 1
    s_and_b32 s29, s28, 3
    s_lshl_b32 s36, s2, 18
    s_lshl_b32 s37, s2, 17
    s_lshl_b32 s38, s29, 12
    v_xor_b32 v130, v128, v129
    v_lshlrev_b32 v130, 4, v130
    v_lshl_add_u32 v130, v129, 9, v130
    v_add_u32 v249, s38, v130
    s_mul_i32 s44, s29, 4224
    s_waitcnt lgkmcnt(0)
    s_add_u32 s8, s20, s36
    s_addc_u32 s9, s21, 0
    s_and_b32 s9, s9, 0xffff
    s_mov_b32 s10, 262144
    s_mov_b32 s11, 0x00020000
    s_cmp_ge_u32 s28, 4
    s_cbranch_scc1 L_pv
    s_add_u32 s4, s22, s37
    s_addc_u32 s5, s23, 0
    s_and_b32 s5, s5, 0xffff
    s_mov_b32 s6, 131072
    s_mov_b32 s7, 0x00020000
    v_lshrrev_b32 v130, 3, v255
    v_lshlrev_b32 v130, 9, v130
    v_and_b32 v131, 7, v255
    v_lshrrev_b32 v132, 4, v255
    v_xor_b32 v131, v131, v132
    v_lshl_add_u32 v133, v131, 4, v130
    v_xor_b32 v134, 64, v133
    s_lshl_b32 s36, s29, 15
    s_lshl_b32 s37, s29, 14
    s_add_u32 s37, s37, 84480
    s_add_u32 m0, s37, 0
    s_add_u32 s38, s36, 0
    buffer_load_dwordx4 v133, s[4:7], s38 offen nt lds
    s_add_u32 m0, s37, 1024
    s_add_u32 s38, s36, 4096
    buffer_load_dwordx4 v134, s[4:7], s38 offen nt lds
    s_add_u32 m0, s37, 2048
    s_add_u32 s38, s36, 8192
    buffer_load_dwordx4 v133, s[4:7], s38 offen nt lds
    s_add_u32 m0, s37, 3072
    s_add_u32 s38, s36, 12288
    buffer_load_dwordx4 v134, s[4:7], s38 offen nt lds
    s_add_u32 m0, s37, 4096
    s_add_u32 s38, s36, 128
    buffer_load_dwordx4 v133, s[4:7], s38 offen nt lds
    s_add_u32 m0, s37, 5120
    s_add_u32 s38, s36, 4224
    buffer_load_dwordx4 v134, s[4:7], s38 offen nt lds
    s_add_u32 m0, s37, 6144
    s_add_u32 s38, s36, 8320
    buffer_load_dwordx4 v133, s[4:7], s38 offen nt lds
    s_add_u32 m0, s37, 7168
    s_add_u32 s38, s36, 12416
    buffer_load_dwordx4 v134, s[4:7], s38 offen nt lds
    s_add_u32 m0, s37, 8192
    s_add_u32 s38, s36, 256
    buffer_load_dwordx4 v133, s[4:7], s38 offen nt lds
    s_add_u32 m0, s37, 9216
    s_add_u32 s38, s36, 4352
    buffer_load_dwordx4 v134, s[4:7], s38 offen nt lds
    s_add_u32 m0, s37, 10240
    s_add_u32 s38, s36, 8448
    buffer_load_dwordx4 v133, s[4:7], s38 offen nt lds
    s_add_u32 m0, s37, 11264
    s_add_u32 s38, s36, 12544
    buffer_load_dwordx4 v134, s[4:7], s38 offen nt lds
    s_add_u32 m0, s37, 12288
    s_add_u32 s38, s36, 384
    buffer_load_dwordx4 v133, s[4:7], s38 offen nt lds
    s_add_u32 m0, s37, 13312
    s_add_u32 s38, s36, 4480
    buffer_load_dwordx4 v134, s[4:7], s38 offen nt lds
    s_add_u32 m0, s37, 14336
    s_add_u32 s38, s36, 8576
    buffer_load_dwordx4 v133, s[4:7], s38 offen nt lds
    s_add_u32 m0, s37, 15360
    s_add_u32 s38, s36, 12672
    buffer_load_dwordx4 v134, s[4:7], s38 offen nt lds
    s_add_u32 m0, s44, 0
    s_mov_b32 s38, 0
    buffer_load_dwordx4 v249, s[8:11], s38 offen nt lds
    s_add_u32 m0, s44, 1056
    s_mov_b32 s38, 1024
    buffer_load_dwordx4 v249, s[8:11], s38 offen nt lds
    s_add_u32 m0, s44, 2112
    s_mov_b32 s38, 2048
    buffer_load_dwordx4 v249, s[8:11], s38 offen nt lds
    s_add_u32 m0, s44, 3168
    s_mov_b32 s38, 3072
    buffer_load_dwordx4 v249, s[8:11], s38 offen nt lds
    s_setprio 1
    v_and_b32 v140, 15, v255
    v_lshrrev_b32 v141, 4, v255
    v_lshrrev_b32 v130, 1, v140
    v_xor_b32 v130, v130, v141
    v_lshlrev_b32 v130, 4, v130
    v_lshl_add_u32 v130, v140, 7, v130
    v_xor_b32 v131, 64, v130
    v_add_u32 v136, s37, v130
    v_add_u32 v137, s37, v131
    v_lshrrev_b32 v130, 1, v140
    v_mul_u32_u24 v130, 1056, v130
    v_and_b32 v131, 1, v140
    v_lshl_add_u32 v130, v131, 9, v130
    v_xor_b32 v131, v131, v141
    v_lshl_add_u32 v250, v131, 4, v130
    v_lshlrev_b32 v130, 4, v140
    v_add_u32 v253, 150528, v130
    v_and_b32 v131, 1, v141
    v_lshl_add_u32 v130, v131, 9, v253
    v_lshl_add_u32 v130, v129, 8, v130
    v_lshlrev_b32 v131, 1, v131
    v_lshrrev_b32 v132, 3, v140
    v_xor_b32 v131, v131, v132
    v_xor_b32 v131, s29, v131
    v_lshl_add_u32 v252, v131, 2, v130
    s_mov_b32 s40, 0x0000ffff
    s_mov_b32 s41, 0x0000ffff
    s_lshl_b32 s38, s29, 12
    s_add_u32 s38, s38, 101376
    v_lshlrev_b32 v130, 4, v255
    v_add_u32 v251, s38, v130
    s_mov_b32 s35, 0x3db8aa3b
    s_mov_b32 s32, 0
    s_mov_b32 s34, 0
    s_waitcnt vmcnt(16)
    ds_read_b128 v[0:3], v136
    ds_read_b128 v[4:7], v137
    ds_read_b128 v[32:35], v136 offset:2048
    ds_read_b128 v[36:39], v137 offset:2048
    s_waitcnt lgkmcnt(0)
    s_add_u32 m0, s37, 0
    s_add_u32 s38, s36, 16384
    buffer_load_dwordx4 v133, s[4:7], s38 offen nt lds
    s_add_u32 m0, s37, 1024
    s_add_u32 s38, s36, 20480
    buffer_load_dwordx4 v134, s[4:7], s38 offen nt lds
    s_add_u32 m0, s37, 2048
    s_add_u32 s38, s36, 24576
    buffer_load_dwordx4 v133, s[4:7], s38 offen nt lds
    s_add_u32 m0, s37, 3072
    s_add_u32 s38, s36, 28672
    buffer_load_dwordx4 v134, s[4:7], s38 offen nt lds
    s_waitcnt vmcnt(16)
    ds_read_b128 v[8:11], v136 offset:4096
    ds_read_b128 v[12:15], v137 offset:4096
    ds_read_b128 v[40:43], v136 offset:6144
    ds_read_b128 v[44:47], v137 offset:6144
    s_waitcnt lgkmcnt(0)
    s_add_u32 m0, s37, 4096
    s_add_u32 s38, s36, 16512
    buffer_load_dwordx4 v133, s[4:7], s38 offen nt lds
    s_add_u32 m0, s37, 5120
    s_add_u32 s38, s36, 20608
    buffer_load_dwordx4 v134, s[4:7], s38 offen nt lds
    s_add_u32 m0, s37, 6144
    s_add_u32 s38, s36, 24704
    buffer_load_dwordx4 v133, s[4:7], s38 offen nt lds
    s_add_u32 m0, s37, 7168
    s_add_u32 s38, s36, 28800
    buffer_load_dwordx4 v134, s[4:7], s38 offen nt lds
    s_waitcnt vmcnt(16)
    ds_read_b128 v[16:19], v136 offset:8192
    ds_read_b128 v[20:23], v137 offset:8192
    ds_read_b128 v[48:51], v136 offset:10240
    ds_read_b128 v[52:55], v137 offset:10240
    s_waitcnt lgkmcnt(0)
    s_add_u32 m0, s37, 8192
    s_add_u32 s38, s36, 16640
    buffer_load_dwordx4 v133, s[4:7], s38 offen nt lds
    s_add_u32 m0, s37, 9216
    s_add_u32 s38, s36, 20736
    buffer_load_dwordx4 v134, s[4:7], s38 offen nt lds
    s_add_u32 m0, s37, 10240
    s_add_u32 s38, s36, 24832
    buffer_load_dwordx4 v133, s[4:7], s38 offen nt lds
    s_add_u32 m0, s37, 11264
    s_add_u32 s38, s36, 28928
    buffer_load_dwordx4 v134, s[4:7], s38 offen nt lds
    s_waitcnt vmcnt(16)
    ds_read_b128 v[24:27], v136 offset:12288
    ds_read_b128 v[28:31], v137 offset:12288
    ds_read_b128 v[56:59], v136 offset:14336
    ds_read_b128 v[60:63], v137 offset:14336
    s_waitcnt lgkmcnt(0)
    s_add_u32 m0, s37, 12288
    s_add_u32 s38, s36, 16768
    buffer_load_dwordx4 v133, s[4:7], s38 offen nt lds
    s_add_u32 m0, s37, 13312
    s_add_u32 s38, s36, 20864
    buffer_load_dwordx4 v134, s[4:7], s38 offen nt lds
    s_add_u32 m0, s37, 14336
    s_add_u32 s38, s36, 24960
    buffer_load_dwordx4 v133, s[4:7], s38 offen nt lds
    s_add_u32 m0, s37, 15360
    s_add_u32 s38, s36, 29056
    buffer_load_dwordx4 v134, s[4:7], s38 offen nt lds
    s_add_u32 m0, s44, 16896
    s_mov_b32 s38, 16384
    buffer_load_dwordx4 v249, s[8:11], s38 offen nt lds
    s_add_u32 m0, s44, 17952
    s_mov_b32 s38, 17408
    buffer_load_dwordx4 v249, s[8:11], s38 offen nt lds
    s_add_u32 m0, s44, 19008
    s_mov_b32 s38, 18432
    buffer_load_dwordx4 v249, s[8:11], s38 offen nt lds
    s_add_u32 m0, s44, 20064
    s_mov_b32 s38, 19456
    buffer_load_dwordx4 v249, s[8:11], s38 offen nt lds
    s_add_u32 m0, s44, 33792
    s_mov_b32 s38, 32768
    buffer_load_dwordx4 v249, s[8:11], s38 offen nt lds
    s_add_u32 m0, s44, 34848
    s_mov_b32 s38, 33792
    buffer_load_dwordx4 v249, s[8:11], s38 offen nt lds
    s_add_u32 m0, s44, 35904
    s_mov_b32 s38, 34816
    buffer_load_dwordx4 v249, s[8:11], s38 offen nt lds
    s_add_u32 m0, s44, 36960
    s_mov_b32 s38, 35840
    buffer_load_dwordx4 v249, s[8:11], s38 offen nt lds
    v_mov_b32 v249, v250
    s_barrier
    s_waitcnt vmcnt(20)
    ds_read_b128 v[64:67], v136
    ds_read_b128 v[68:71], v137
    ds_read_b128 v[96:99], v136 offset:2048
    ds_read_b128 v[100:103], v137 offset:2048
    s_waitcnt vmcnt(16)
    ds_read_b128 v[72:75], v136 offset:4096
    ds_read_b128 v[76:79], v137 offset:4096
    ds_read_b128 v[104:107], v136 offset:6144
    ds_read_b128 v[108:111], v137 offset:6144
    s_waitcnt vmcnt(12)
    ds_read_b128 v[80:83], v136 offset:8192
    ds_read_b128 v[84:87], v137 offset:8192
    ds_read_b128 v[112:115], v136 offset:10240
    ds_read_b128 v[116:119], v137 offset:10240
    s_waitcnt vmcnt(8)
    ds_read_b128 v[88:91], v136 offset:12288
    ds_read_b128 v[92:95], v137 offset:12288
    ds_read_b128 v[120:123], v136 offset:14336
    s_waitcnt lgkmcnt(14)
    ds_read_b128 v[124:127], v137 offset:14336
    s_waitcnt lgkmcnt(0)
    s_barrier
    ds_read_b128 v[192:195], v249
    ds_read_b128 v[196:199], v249 offset:8448
    ds_read_b128 v[200:203], v249 offset:64
    ds_read_b128 v[204:207], v249 offset:8512
    ds_read_b128 v[208:211], v249 offset:128
    v_mov_b32 v242, 0
    v_mov_b32 v243, 0
    s_waitcnt lgkmcnt(4)
    v_mfma_f32_16x16x32_bf16 v[128:131], v[0:3], v[192:195], 0
    v_mfma_f32_16x16x32_bf16 v[132:135], v[32:35], v[192:195], 0
    v_mfma_f32_16x16x32_bf16 v[136:139], v[64:67], v[192:195], 0
    v_mfma_f32_16x16x32_bf16 v[140:143], v[96:99], v[192:195], 0
    ds_read_b128 v[212:215], v249 offset:8576
    s_waitcnt lgkmcnt(4)
    v_mfma_f32_16x16x32_bf16 v[144:147], v[0:3], v[196:199], 0
    v_mfma_f32_16x16x32_bf16 v[148:151], v[32:35], v[196:199], 0
    v_mfma_f32_16x16x32_bf16 v[152:155], v[64:67], v[196:199], 0
    v_mfma_f32_16x16x32_bf16 v[156:159], v[96:99], v[196:199], 0
    ds_read_b128 v[216:219], v249 offset:192
    s_waitcnt lgkmcnt(4)
    v_mfma_f32_16x16x32_bf16 v[128:131], v[4:7], v[200:203], v[128:131]
    v_mfma_f32_16x16x32_bf16 v[132:135], v[36:39], v[200:203], v[132:135]
    v_mfma_f32_16x16x32_bf16 v[136:139], v[68:71], v[200:203], v[136:139]
    v_mfma_f32_16x16x32_bf16 v[140:143], v[100:103], v[200:203], v[140:143]
    ds_read_b128 v[220:223], v249 offset:8640
    s_waitcnt lgkmcnt(4)
    v_mfma_f32_16x16x32_bf16 v[144:147], v[4:7], v[204:207], v[144:147]
    v_mfma_f32_16x16x32_bf16 v[148:151], v[36:39], v[204:207], v[148:151]
    v_mfma_f32_16x16x32_bf16 v[152:155], v[68:71], v[204:207], v[152:155]
    v_mfma_f32_16x16x32_bf16 v[156:159], v[100:103], v[204:207], v[156:159]
    ds_read_b128 v[192:195], v249 offset:256
    s_waitcnt lgkmcnt(4)
    v_mfma_f32_16x16x32_bf16 v[128:131], v[8:11], v[208:211], v[128:131]
    v_mfma_f32_16x16x32_bf16 v[132:135], v[40:43], v[208:211], v[132:135]
    v_mfma_f32_16x16x32_bf16 v[136:139], v[72:75], v[208:211], v[136:139]
    v_mfma_f32_16x16x32_bf16 v[140:143], v[104:107], v[208:211], v[140:143]
    ds_read_b128 v[196:199], v249 offset:8704
    s_waitcnt lgkmcnt(4)
    v_mfma_f32_16x16x32_bf16 v[144:147], v[8:11], v[212:215], v[144:147]
    v_mfma_f32_16x16x32_bf16 v[148:151], v[40:43], v[212:215], v[148:151]
    v_mfma_f32_16x16x32_bf16 v[152:155], v[72:75], v[212:215], v[152:155]
    v_mfma_f32_16x16x32_bf16 v[156:159], v[104:107], v[212:215], v[156:159]
    ds_read_b128 v[200:203], v249 offset:320
    s_waitcnt lgkmcnt(4)
    v_mfma_f32_16x16x32_bf16 v[128:131], v[12:15], v[216:219], v[128:131]
    v_mfma_f32_16x16x32_bf16 v[132:135], v[44:47], v[216:219], v[132:135]
    v_mfma_f32_16x16x32_bf16 v[136:139], v[76:79], v[216:219], v[136:139]
    v_mfma_f32_16x16x32_bf16 v[140:143], v[108:111], v[216:219], v[140:143]
    ds_read_b128 v[204:207], v249 offset:8768
    s_waitcnt lgkmcnt(4)
    v_mfma_f32_16x16x32_bf16 v[144:147], v[12:15], v[220:223], v[144:147]
    v_mfma_f32_16x16x32_bf16 v[148:151], v[44:47], v[220:223], v[148:151]
    v_mfma_f32_16x16x32_bf16 v[152:155], v[76:79], v[220:223], v[152:155]
    v_mfma_f32_16x16x32_bf16 v[156:159], v[108:111], v[220:223], v[156:159]
    ds_read_b128 v[208:211], v249 offset:384
    s_waitcnt lgkmcnt(4)
    v_mfma_f32_16x16x32_bf16 v[128:131], v[16:19], v[192:195], v[128:131]
    v_mfma_f32_16x16x32_bf16 v[132:135], v[48:51], v[192:195], v[132:135]
    v_mfma_f32_16x16x32_bf16 v[136:139], v[80:83], v[192:195], v[136:139]
    v_mfma_f32_16x16x32_bf16 v[140:143], v[112:115], v[192:195], v[140:143]
    ds_read_b128 v[212:215], v249 offset:8832
    s_waitcnt lgkmcnt(4)
    v_mfma_f32_16x16x32_bf16 v[144:147], v[16:19], v[196:199], v[144:147]
    v_mfma_f32_16x16x32_bf16 v[148:151], v[48:51], v[196:199], v[148:151]
    v_mfma_f32_16x16x32_bf16 v[152:155], v[80:83], v[196:199], v[152:155]
    v_mfma_f32_16x16x32_bf16 v[156:159], v[112:115], v[196:199], v[156:159]
    ds_read_b128 v[216:219], v249 offset:448
    s_waitcnt lgkmcnt(4)
    v_mfma_f32_16x16x32_bf16 v[128:131], v[20:23], v[200:203], v[128:131]
    v_mfma_f32_16x16x32_bf16 v[132:135], v[52:55], v[200:203], v[132:135]
    v_mfma_f32_16x16x32_bf16 v[136:139], v[84:87], v[200:203], v[136:139]
    v_mfma_f32_16x16x32_bf16 v[140:143], v[116:119], v[200:203], v[140:143]
    ds_read_b128 v[220:223], v249 offset:8896
    s_waitcnt lgkmcnt(4)
    v_mfma_f32_16x16x32_bf16 v[144:147], v[20:23], v[204:207], v[144:147]
    v_mfma_f32_16x16x32_bf16 v[148:151], v[52:55], v[204:207], v[148:151]
    v_mfma_f32_16x16x32_bf16 v[152:155], v[84:87], v[204:207], v[152:155]
    v_mfma_f32_16x16x32_bf16 v[156:159], v[116:119], v[204:207], v[156:159]
    s_add_u32 s32, s32, 16896
    s_cmp_eq_u32 s32, 101376
    s_cselect_b32 s32, 0, s32
    v_add_u32 v249, s32, v250
    s_waitcnt lgkmcnt(3)
    v_mfma_f32_16x16x32_bf16 v[128:131], v[24:27], v[208:211], v[128:131]
    v_mfma_f32_16x16x32_bf16 v[132:135], v[56:59], v[208:211], v[132:135]
    v_mfma_f32_16x16x32_bf16 v[136:139], v[88:91], v[208:211], v[136:139]
    v_mfma_f32_16x16x32_bf16 v[140:143], v[120:123], v[208:211], v[140:143]
    s_waitcnt lgkmcnt(2)
    v_mfma_f32_16x16x32_bf16 v[144:147], v[24:27], v[212:215], v[144:147]
    v_mfma_f32_16x16x32_bf16 v[148:151], v[56:59], v[212:215], v[148:151]
    v_mfma_f32_16x16x32_bf16 v[152:155], v[88:91], v[212:215], v[152:155]
    v_mfma_f32_16x16x32_bf16 v[156:159], v[120:123], v[212:215], v[156:159]
    s_waitcnt lgkmcnt(1)
    v_mfma_f32_16x16x32_bf16 v[128:131], v[28:31], v[216:219], v[128:131]
    v_mfma_f32_16x16x32_bf16 v[132:135], v[60:63], v[216:219], v[132:135]
    v_mfma_f32_16x16x32_bf16 v[136:139], v[92:95], v[216:219], v[136:139]
    v_mfma_f32_16x16x32_bf16 v[140:143], v[124:127], v[216:219], v[140:143]
    s_waitcnt lgkmcnt(0)
    v_mfma_f32_16x16x32_bf16 v[144:147], v[28:31], v[220:223], v[144:147]
    v_mfma_f32_16x16x32_bf16 v[148:151], v[60:63], v[220:223], v[148:151]
    v_mfma_f32_16x16x32_bf16 v[152:155], v[92:95], v[220:223], v[152:155]
    v_mfma_f32_16x16x32_bf16 v[156:159], v[124:127], v[220:223], v[156:159]
    v_max3_f32 v244, v128, v129, v130
    s_nop 3
    v_max3_f32 v245, v144, v145, v146
    v_max3_f32 v244, v244, v131, v132
    v_max3_f32 v245, v245, v147, v148
    v_max3_f32 v244, v244, v133, v134
    v_max3_f32 v245, v245, v149, v150
    v_max3_f32 v244, v244, v135, v136
    v_max3_f32 v245, v245, v151, v152
    v_max3_f32 v244, v244, v137, v138
    v_max3_f32 v245, v245, v153, v154
    v_max3_f32 v244, v244, v139, v140
    v_max3_f32 v245, v245, v155, v156
    v_max3_f32 v244, v244, v141, v142
    v_max3_f32 v245, v245, v157, v158
    v_max_f32 v244, v244, v143
    v_max_f32 v245, v245, v159
    s_nop 1
    v_permlane32_swap_b32 v244, v245
    v_permlane32_swap_b32 v242, v243
    v_max_f32 v244, v244, v245
    v_add_f32 v242, v242, v243
    s_nop 1
    v_permlane16_swap_b32 v244, v242
    v_max_f32 v246, v244, v242
    v_add_f32 v247, v244, v242
    v_cndmask_b32 v246, v247, v246, s[40:41]
    ds_write_b32 v252, v246 offset:1024
    s_waitcnt vmcnt(4) lgkmcnt(0)
    s_barrier
    s_add_u32 s34, s34, 1
    s_waitcnt lgkmcnt(0)
    ds_read_b128 v[192:195], v249
    ds_read_b128 v[196:199], v249 offset:8448
    ds_read_b128 v[200:203], v249 offset:64
    ds_read_b128 v[204:207], v249 offset:8512
    ds_read_b128 v[208:211], v249 offset:128
    ds_read_b128 v[232:235], v253 offset:1024
    ds_read_b128 v[224:227], v253 offset:1280
    s_waitcnt lgkmcnt(6)
    v_mfma_f32_16x16x32_bf16 v[160:163], v[0:3], v[192:195], 0
    v_mfma_f32_16x16x32_bf16 v[164:167], v[32:35], v[192:195], 0
    v_mfma_f32_16x16x32_bf16 v[168:171], v[64:67], v[192:195], 0
    v_mfma_f32_16x16x32_bf16 v[172:175], v[96:99], v[192:195], 0
    ds_read_b128 v[212:215], v249 offset:8576
    s_waitcnt lgkmcnt(6)
    v_mfma_f32_16x16x32_bf16 v[176:179], v[0:3], v[196:199], 0
    v_mfma_f32_16x16x32_bf16 v[180:183], v[32:35], v[196:199], 0
    v_mfma_f32_16x16x32_bf16 v[184:187], v[64:67], v[196:199], 0
    v_mfma_f32_16x16x32_bf16 v[188:191], v[96:99], v[196:199], 0
    ds_read_b128 v[216:219], v249 offset:192
    s_waitcnt lgkmcnt(3)
    v_max3_f32 v246, v232, v233, v234
    v_max_f32 v246, v246, v235
    v_mul_f32 v240, s35, v246
    s_waitcnt lgkmcnt(2)
    v_max3_f32 v246, v224, v225, v226
    v_max_f32 v246, v246, v227
    v_mul_f32 v241, s35, v246
    v_mfma_f32_16x16x32_bf16 v[160:163], v[4:7], v[200:203], v[160:163]
    v_fma_f32 v128, v128, s35, -v240
    v_fma_f32 v129, v129, s35, -v240
    v_mfma_f32_16x16x32_bf16 v[164:167], v[36:39], v[200:203], v[164:167]
    v_exp_f32 v128, v128
    v_exp_f32 v129, v129
    v_mfma_f32_16x16x32_bf16 v[168:171], v[68:71], v[200:203], v[168:171]
    v_mfma_f32_16x16x32_bf16 v[172:175], v[100:103], v[200:203], v[172:175]
    ds_read_b128 v[220:223], v249 offset:8640
    v_fma_f32 v130, v130, s35, -v240
    v_fma_f32 v131, v131, s35, -v240
    v_add_f32 v242, v128, v129
    v_cvt_pk_bf16_f32 v224, v128, v129
    v_mfma_f32_16x16x32_bf16 v[176:179], v[4:7], v[204:207], v[176:179]
    v_exp_f32 v130, v130
    v_exp_f32 v131, v131
    v_mfma_f32_16x16x32_bf16 v[180:183], v[36:39], v[204:207], v[180:183]
    v_mfma_f32_16x16x32_bf16 v[184:187], v[68:71], v[204:207], v[184:187]
    v_fma_f32 v132, v132, s35, -v240
    v_fma_f32 v133, v133, s35, -v240
    v_add_f32 v242, v242, v130
    v_add_f32 v242, v242, v131
    v_cvt_pk_bf16_f32 v225, v130, v131
    v_mfma_f32_16x16x32_bf16 v[188:191], v[100:103], v[204:207], v[188:191]
    ds_read_b128 v[192:195], v249 offset:256
    v_mfma_f32_16x16x32_bf16 v[160:163], v[8:11], v[208:211], v[160:163]
    v_exp_f32 v132, v132
    v_exp_f32 v133, v133
    v_mfma_f32_16x16x32_bf16 v[164:167], v[40:43], v[208:211], v[164:167]
    v_fma_f32 v134, v134, s35, -v240
    v_fma_f32 v135, v135, s35, -v240
    v_add_f32 v242, v242, v132
    v_add_f32 v242, v242, v133
    v_cvt_pk_bf16_f32 v226, v132, v133
    v_mfma_f32_16x16x32_bf16 v[168:171], v[72:75], v[208:211], v[168:171]
    v_mfma_f32_16x16x32_bf16 v[172:175], v[104:107], v[208:211], v[172:175]
    ds_read_b128 v[196:199], v249 offset:8704
    v_exp_f32 v134, v134
    v_exp_f32 v135, v135
    s_waitcnt lgkmcnt(4)
    v_mfma_f32_16x16x32_bf16 v[176:179], v[8:11], v[212:215], v[176:179]
    v_mfma_f32_16x16x32_bf16 v[180:183], v[40:43], v[212:215], v[180:183]
    v_fma_f32 v136, v136, s35, -v240
    v_fma_f32 v137, v137, s35, -v240
    v_add_f32 v242, v242, v134
    v_add_f32 v242, v242, v135
    v_cvt_pk_bf16_f32 v227, v134, v135
    ds_write_b128 v251, v[224:227]
    v_mfma_f32_16x16x32_bf16 v[184:187], v[72:75], v[212:215], v[184:187]
    v_exp_f32 v136, v136
    v_exp_f32 v137, v137
    v_mfma_f32_16x16x32_bf16 v[188:191], v[104:107], v[212:215], v[188:191]
    ds_read_b128 v[200:203], v249 offset:320
    s_waitcnt lgkmcnt(5)
    v_mfma_f32_16x16x32_bf16 v[160:163], v[12:15], v[216:219], v[160:163]
    v_fma_f32 v138, v138, s35, -v240
    v_fma_f32 v139, v139, s35, -v240
    v_add_f32 v242, v242, v136
    v_add_f32 v242, v242, v137
    v_cvt_pk_bf16_f32 v228, v136, v137
    v_mfma_f32_16x16x32_bf16 v[164:167], v[44:47], v[216:219], v[164:167]
    v_mfma_f32_16x16x32_bf16 v[168:171], v[76:79], v[216:219], v[168:171]
    v_exp_f32 v138, v138
    v_exp_f32 v139, v139
    v_mfma_f32_16x16x32_bf16 v[172:175], v[108:111], v[216:219], v[172:175]
    ds_read_b128 v[204:207], v249 offset:8768
    v_fma_f32 v140, v140, s35, -v240
    v_fma_f32 v141, v141, s35, -v240
    v_add_f32 v242, v242, v138
    v_add_f32 v242, v242, v139
    v_cvt_pk_bf16_f32 v229, v138, v139
    s_waitcnt lgkmcnt(5)
    v_mfma_f32_16x16x32_bf16 v[176:179], v[12:15], v[220:223], v[176:179]
    v_mfma_f32_16x16x32_bf16 v[180:183], v[44:47], v[220:223], v[180:183]
    v_exp_f32 v140, v140
    v_exp_f32 v141, v141
    v_mfma_f32_16x16x32_bf16 v[184:187], v[76:79], v[220:223], v[184:187]
    v_fma_f32 v142, v142, s35, -v240
    v_fma_f32 v143, v143, s35, -v240
    v_add_f32 v242, v242, v140
    v_add_f32 v242, v242, v141
    v_cvt_pk_bf16_f32 v230, v140, v141
    v_mfma_f32_16x16x32_bf16 v[188:191], v[108:111], v[220:223], v[188:191]
    ds_read_b128 v[208:211], v249 offset:384
    s_waitcnt lgkmcnt(5)
    v_mfma_f32_16x16x32_bf16 v[160:163], v[16:19], v[192:195], v[160:163]
    v_exp_f32 v142, v142
    v_exp_f32 v143, v143
    v_mfma_f32_16x16x32_bf16 v[164:167], v[48:51], v[192:195], v[164:167]
    v_mfma_f32_16x16x32_bf16 v[168:171], v[80:83], v[192:195], v[168:171]
    v_fma_f32 v144, v144, s35, -v241
    v_fma_f32 v145, v145, s35, -v241
    v_add_f32 v242, v242, v142
    v_add_f32 v242, v242, v143
    v_cvt_pk_bf16_f32 v231, v142, v143
    ds_write_b128 v251, v[228:231] offset:2048
    v_mfma_f32_16x16x32_bf16 v[172:175], v[112:115], v[192:195], v[172:175]
    ds_read_b128 v[212:215], v249 offset:8832
    v_exp_f32 v144, v144
    v_exp_f32 v145, v145
    s_waitcnt lgkmcnt(6)
    v_mfma_f32_16x16x32_bf16 v[176:179], v[16:19], v[196:199], v[176:179]
    v_mfma_f32_16x16x32_bf16 v[180:183], v[48:51], v[196:199], v[180:183]
    v_fma_f32 v146, v146, s35, -v241
    v_fma_f32 v147, v147, s35, -v241
    v_add_f32 v243, v144, v145
    v_cvt_pk_bf16_f32 v224, v144, v145
    v_mfma_f32_16x16x32_bf16 v[184:187], v[80:83], v[196:199], v[184:187]
    v_mfma_f32_16x16x32_bf16 v[188:191], v[112:115], v[196:199], v[188:191]
    ds_read_b128 v[216:219], v249 offset:448
    v_exp_f32 v146, v146
    v_exp_f32 v147, v147
    s_waitcnt lgkmcnt(5)
    v_mfma_f32_16x16x32_bf16 v[160:163], v[20:23], v[200:203], v[160:163]
    v_fma_f32 v148, v148, s35, -v241
    v_fma_f32 v149, v149, s35, -v241
    v_add_f32 v243, v243, v146
    v_add_f32 v243, v243, v147
    v_cvt_pk_bf16_f32 v225, v146, v147
    v_mfma_f32_16x16x32_bf16 v[164:167], v[52:55], v[200:203], v[164:167]
    v_mfma_f32_16x16x32_bf16 v[168:171], v[84:87], v[200:203], v[168:171]
    v_exp_f32 v148, v148
    v_exp_f32 v149, v149
    v_mfma_f32_16x16x32_bf16 v[172:175], v[116:119], v[200:203], v[172:175]
    ds_read_b128 v[220:223], v249 offset:8896
    s_waitcnt lgkmcnt(5)
    v_mfma_f32_16x16x32_bf16 v[176:179], v[20:23], v[204:207], v[176:179]
    v_fma_f32 v150, v150, s35, -v241
    v_fma_f32 v151, v151, s35, -v241
    v_add_f32 v243, v243, v148
    v_add_f32 v243, v243, v149
    v_cvt_pk_bf16_f32 v226, v148, v149
    v_mfma_f32_16x16x32_bf16 v[180:183], v[52:55], v[204:207], v[180:183]
    v_exp_f32 v150, v150
    v_exp_f32 v151, v151
    v_mfma_f32_16x16x32_bf16 v[184:187], v[84:87], v[204:207], v[184:187]
    v_mfma_f32_16x16x32_bf16 v[188:191], v[116:119], v[204:207], v[188:191]
    s_add_u32 s32, s32, 16896
    s_cmp_eq_u32 s32, 101376
    s_cselect_b32 s32, 0, s32
    v_add_u32 v249, s32, v250
    v_fma_f32 v152, v152, s35, -v241
    v_fma_f32 v153, v153, s35, -v241
    v_add_f32 v243, v243, v150
    v_add_f32 v243, v243, v151
    v_cvt_pk_bf16_f32 v227, v150, v151
    ds_write_b128 v251, v[224:227] offset:1024
    s_waitcnt lgkmcnt(5)
    v_mfma_f32_16x16x32_bf16 v[160:163], v[24:27], v[208:211], v[160:163]
    v_exp_f32 v152, v152
    v_exp_f32 v153, v153
    v_mfma_f32_16x16x32_bf16 v[164:167], v[56:59], v[208:211], v[164:167]
    v_mfma_f32_16x16x32_bf16 v[168:171], v[88:91], v[208:211], v[168:171]
    v_fma_f32 v154, v154, s35, -v241
    v_fma_f32 v155, v155, s35, -v241
    v_add_f32 v243, v243, v152
    v_add_f32 v243, v243, v153
    v_cvt_pk_bf16_f32 v228, v152, v153
    v_mfma_f32_16x16x32_bf16 v[172:175], v[120:123], v[208:211], v[172:175]
    s_waitcnt lgkmcnt(3)
    v_mfma_f32_16x16x32_bf16 v[176:179], v[24:27], v[212:215], v[176:179]
    v_exp_f32 v154, v154
    v_exp_f32 v155, v155
    v_mfma_f32_16x16x32_bf16 v[180:183], v[56:59], v[212:215], v[180:183]
    v_fma_f32 v156, v156, s35, -v241
    v_fma_f32 v157, v157, s35, -v241
    v_add_f32 v243, v243, v154
    v_add_f32 v243, v243, v155
    v_cvt_pk_bf16_f32 v229, v154, v155
    v_mfma_f32_16x16x32_bf16 v[184:187], v[88:91], v[212:215], v[184:187]
    v_mfma_f32_16x16x32_bf16 v[188:191], v[120:123], v[212:215], v[188:191]
    v_exp_f32 v156, v156
    v_exp_f32 v157, v157
    s_waitcnt lgkmcnt(2)
    v_mfma_f32_16x16x32_bf16 v[160:163], v[28:31], v[216:219], v[160:163]
    v_mfma_f32_16x16x32_bf16 v[164:167], v[60:63], v[216:219], v[164:167]
    v_fma_f32 v158, v158, s35, -v241
    v_fma_f32 v159, v159, s35, -v241
    v_add_f32 v243, v243, v156
    v_add_f32 v243, v243, v157
    v_cvt_pk_bf16_f32 v230, v156, v157
    v_mfma_f32_16x16x32_bf16 v[168:171], v[92:95], v[216:219], v[168:171]
    v_exp_f32 v158, v158
    v_exp_f32 v159, v159
    v_mfma_f32_16x16x32_bf16 v[172:175], v[124:127], v[216:219], v[172:175]
    s_waitcnt lgkmcnt(1)
    v_mfma_f32_16x16x32_bf16 v[176:179], v[28:31], v[220:223], v[176:179]
    v_add_f32 v243, v243, v158
    v_add_f32 v243, v243, v159
    v_cvt_pk_bf16_f32 v231, v158, v159
    ds_write_b128 v251, v[228:231] offset:3072
    v_mfma_f32_16x16x32_bf16 v[180:183], v[60:63], v[220:223], v[180:183]
    v_mfma_f32_16x16x32_bf16 v[184:187], v[92:95], v[220:223], v[184:187]
    v_mfma_f32_16x16x32_bf16 v[188:191], v[124:127], v[220:223], v[188:191]
    v_max3_f32 v244, v160, v161, v162
    v_max3_f32 v245, v176, v177, v178
    v_max3_f32 v244, v244, v163, v164
    s_nop 2
    v_max3_f32 v245, v245, v179, v180
    v_max3_f32 v244, v244, v165, v166
    v_max3_f32 v245, v245, v181, v182
    v_max3_f32 v244, v244, v167, v168
    v_max3_f32 v245, v245, v183, v184
    v_max3_f32 v244, v244, v169, v170
    v_max3_f32 v245, v245, v185, v186
    v_max3_f32 v244, v244, v171, v172
    v_max3_f32 v245, v245, v187, v188
    v_max3_f32 v244, v244, v173, v174
    v_max3_f32 v245, v245, v189, v190
    v_max_f32 v244, v244, v175
    v_max_f32 v245, v245, v191
    s_nop 1
    v_permlane32_swap_b32 v244, v245
    v_permlane32_swap_b32 v242, v243
    v_max_f32 v244, v244, v245
    v_add_f32 v242, v242, v243
    s_nop 1
    v_permlane16_swap_b32 v244, v242
    v_max_f32 v246, v244, v242
    v_add_f32 v247, v244, v242
    v_cndmask_b32 v246, v247, v246, s[40:41]
    ds_write_b32 v252, v246
    s_waitcnt vmcnt(0) lgkmcnt(0)
    s_barrier
    s_add_u32 s34, s34, 1
    s_waitcnt lgkmcnt(0)
    ds_read_b128 v[192:195], v249
    ds_read_b128 v[196:199], v249 offset:8448
    ds_read_b128 v[200:203], v249 offset:64
    ds_read_b128 v[204:207], v249 offset:8512
    ds_read_b128 v[208:211], v249 offset:128
    ds_read_b128 v[232:235], v253
    ds_read_b128 v[224:227], v253 offset:256
    s_waitcnt lgkmcnt(6)
    v_mfma_f32_16x16x32_bf16 v[128:131], v[0:3], v[192:195], 0
    v_mfma_f32_16x16x32_bf16 v[132:135], v[32:35], v[192:195], 0
    v_mfma_f32_16x16x32_bf16 v[136:139], v[64:67], v[192:195], 0
    v_mfma_f32_16x16x32_bf16 v[140:143], v[96:99], v[192:195], 0
    ds_read_b128 v[212:215], v249 offset:8576
    s_waitcnt lgkmcnt(6)
    v_mfma_f32_16x16x32_bf16 v[144:147], v[0:3], v[196:199], 0
    v_mfma_f32_16x16x32_bf16 v[148:151], v[32:35], v[196:199], 0
    v_mfma_f32_16x16x32_bf16 v[152:155], v[64:67], v[196:199], 0
    v_mfma_f32_16x16x32_bf16 v[156:159], v[96:99], v[196:199], 0
    ds_read_b128 v[216:219], v249 offset:192
    s_waitcnt lgkmcnt(3)
    v_max3_f32 v246, v232, v233, v234
    v_max_f32 v246, v246, v235
    v_mul_f32 v240, s35, v246
    s_waitcnt lgkmcnt(2)
    v_max3_f32 v246, v224, v225, v226
    v_max_f32 v246, v246, v227
    v_mul_f32 v241, s35, v246
    v_mfma_f32_16x16x32_bf16 v[128:131], v[4:7], v[200:203], v[128:131]
    v_fma_f32 v160, v160, s35, -v240
    v_fma_f32 v161, v161, s35, -v240
    v_mfma_f32_16x16x32_bf16 v[132:135], v[36:39], v[200:203], v[132:135]
    v_exp_f32 v160, v160
    v_exp_f32 v161, v161
    v_mfma_f32_16x16x32_bf16 v[136:139], v[68:71], v[200:203], v[136:139]
    v_mfma_f32_16x16x32_bf16 v[140:143], v[100:103], v[200:203], v[140:143]
    ds_read_b128 v[220:223], v249 offset:8640
    v_fma_f32 v162, v162, s35, -v240
    v_fma_f32 v163, v163, s35, -v240
    v_add_f32 v242, v160, v161
    v_cvt_pk_bf16_f32 v224, v160, v161
    v_mfma_f32_16x16x32_bf16 v[144:147], v[4:7], v[204:207], v[144:147]
    v_exp_f32 v162, v162
    v_exp_f32 v163, v163
    v_mfma_f32_16x16x32_bf16 v[148:151], v[36:39], v[204:207], v[148:151]
    v_mfma_f32_16x16x32_bf16 v[152:155], v[68:71], v[204:207], v[152:155]
    v_fma_f32 v164, v164, s35, -v240
    v_fma_f32 v165, v165, s35, -v240
    v_add_f32 v242, v242, v162
    v_add_f32 v242, v242, v163
    v_cvt_pk_bf16_f32 v225, v162, v163
    v_mfma_f32_16x16x32_bf16 v[156:159], v[100:103], v[204:207], v[156:159]
    ds_read_b128 v[192:195], v249 offset:256
    v_mfma_f32_16x16x32_bf16 v[128:131], v[8:11], v[208:211], v[128:131]
    v_exp_f32 v164, v164
    v_exp_f32 v165, v165
    v_mfma_f32_16x16x32_bf16 v[132:135], v[40:43], v[208:211], v[132:135]
    v_fma_f32 v166, v166, s35, -v240
    v_fma_f32 v167, v167, s35, -v240
    v_add_f32 v242, v242, v164
    v_add_f32 v242, v242, v165
    v_cvt_pk_bf16_f32 v226, v164, v165
    v_mfma_f32_16x16x32_bf16 v[136:139], v[72:75], v[208:211], v[136:139]
    v_mfma_f32_16x16x32_bf16 v[140:143], v[104:107], v[208:211], v[140:143]
    ds_read_b128 v[196:199], v249 offset:8704
    v_exp_f32 v166, v166
    v_exp_f32 v167, v167
    s_waitcnt lgkmcnt(4)
    v_mfma_f32_16x16x32_bf16 v[144:147], v[8:11], v[212:215], v[144:147]
    v_mfma_f32_16x16x32_bf16 v[148:151], v[40:43], v[212:215], v[148:151]
    v_fma_f32 v168, v168, s35, -v240
    v_fma_f32 v169, v169, s35, -v240
    v_add_f32 v242, v242, v166
    v_add_f32 v242, v242, v167
    v_cvt_pk_bf16_f32 v227, v166, v167
    ds_write_b128 v251, v[224:227] offset:16384
    v_mfma_f32_16x16x32_bf16 v[152:155], v[72:75], v[212:215], v[152:155]
    v_exp_f32 v168, v168
    v_exp_f32 v169, v169
    v_mfma_f32_16x16x32_bf16 v[156:159], v[104:107], v[212:215], v[156:159]
    ds_read_b128 v[200:203], v249 offset:320
    s_waitcnt lgkmcnt(5)
    v_mfma_f32_16x16x32_bf16 v[128:131], v[12:15], v[216:219], v[128:131]
    v_fma_f32 v170, v170, s35, -v240
    v_fma_f32 v171, v171, s35, -v240
    v_add_f32 v242, v242, v168
    v_add_f32 v242, v242, v169
    v_cvt_pk_bf16_f32 v228, v168, v169
    v_mfma_f32_16x16x32_bf16 v[132:135], v[44:47], v[216:219], v[132:135]
    v_mfma_f32_16x16x32_bf16 v[136:139], v[76:79], v[216:219], v[136:139]
    v_exp_f32 v170, v170
    v_exp_f32 v171, v171
    v_mfma_f32_16x16x32_bf16 v[140:143], v[108:111], v[216:219], v[140:143]
    ds_read_b128 v[204:207], v249 offset:8768
    v_fma_f32 v172, v172, s35, -v240
    v_fma_f32 v173, v173, s35, -v240
    v_add_f32 v242, v242, v170
    v_add_f32 v242, v242, v171
    v_cvt_pk_bf16_f32 v229, v170, v171
    s_waitcnt lgkmcnt(5)
    v_mfma_f32_16x16x32_bf16 v[144:147], v[12:15], v[220:223], v[144:147]
    v_mfma_f32_16x16x32_bf16 v[148:151], v[44:47], v[220:223], v[148:151]
    v_exp_f32 v172, v172
    v_exp_f32 v173, v173
    v_mfma_f32_16x16x32_bf16 v[152:155], v[76:79], v[220:223], v[152:155]
    v_fma_f32 v174, v174, s35, -v240
    v_fma_f32 v175, v175, s35, -v240
    v_add_f32 v242, v242, v172
    v_add_f32 v242, v242, v173
    v_cvt_pk_bf16_f32 v230, v172, v173
    v_mfma_f32_16x16x32_bf16 v[156:159], v[108:111], v[220:223], v[156:159]
    ds_read_b128 v[208:211], v249 offset:384
    s_waitcnt lgkmcnt(5)
    v_mfma_f32_16x16x32_bf16 v[128:131], v[16:19], v[192:195], v[128:131]
    v_exp_f32 v174, v174
    v_exp_f32 v175, v175
    v_mfma_f32_16x16x32_bf16 v[132:135], v[48:51], v[192:195], v[132:135]
    v_mfma_f32_16x16x32_bf16 v[136:139], v[80:83], v[192:195], v[136:139]
    v_fma_f32 v176, v176, s35, -v241
    v_fma_f32 v177, v177, s35, -v241
    v_add_f32 v242, v242, v174
    v_add_f32 v242, v242, v175
    v_cvt_pk_bf16_f32 v231, v174, v175
    ds_write_b128 v251, v[228:231] offset:18432
    v_mfma_f32_16x16x32_bf16 v[140:143], v[112:115], v[192:195], v[140:143]
    ds_read_b128 v[212:215], v249 offset:8832
    v_exp_f32 v176, v176
    v_exp_f32 v177, v177
    s_waitcnt lgkmcnt(6)
    v_mfma_f32_16x16x32_bf16 v[144:147], v[16:19], v[196:199], v[144:147]
    v_mfma_f32_16x16x32_bf16 v[148:151], v[48:51], v[196:199], v[148:151]
    v_fma_f32 v178, v178, s35, -v241
    v_fma_f32 v179, v179, s35, -v241
    v_add_f32 v243, v176, v177
    v_cvt_pk_bf16_f32 v224, v176, v177
    v_mfma_f32_16x16x32_bf16 v[152:155], v[80:83], v[196:199], v[152:155]
    v_mfma_f32_16x16x32_bf16 v[156:159], v[112:115], v[196:199], v[156:159]
    ds_read_b128 v[216:219], v249 offset:448
    v_exp_f32 v178, v178
    v_exp_f32 v179, v179
    s_waitcnt lgkmcnt(5)
    v_mfma_f32_16x16x32_bf16 v[128:131], v[20:23], v[200:203], v[128:131]
    v_fma_f32 v180, v180, s35, -v241
    v_fma_f32 v181, v181, s35, -v241
    v_add_f32 v243, v243, v178
    v_add_f32 v243, v243, v179
    v_cvt_pk_bf16_f32 v225, v178, v179
    v_mfma_f32_16x16x32_bf16 v[132:135], v[52:55], v[200:203], v[132:135]
    v_mfma_f32_16x16x32_bf16 v[136:139], v[84:87], v[200:203], v[136:139]
    v_exp_f32 v180, v180
    v_exp_f32 v181, v181
    v_mfma_f32_16x16x32_bf16 v[140:143], v[116:119], v[200:203], v[140:143]
    ds_read_b128 v[220:223], v249 offset:8896
    s_waitcnt lgkmcnt(5)
    v_mfma_f32_16x16x32_bf16 v[144:147], v[20:23], v[204:207], v[144:147]
    v_fma_f32 v182, v182, s35, -v241
    v_fma_f32 v183, v183, s35, -v241
    v_add_f32 v243, v243, v180
    v_add_f32 v243, v243, v181
    v_cvt_pk_bf16_f32 v226, v180, v181
    v_mfma_f32_16x16x32_bf16 v[148:151], v[52:55], v[204:207], v[148:151]
    v_exp_f32 v182, v182
    v_exp_f32 v183, v183
    v_mfma_f32_16x16x32_bf16 v[152:155], v[84:87], v[204:207], v[152:155]
    v_mfma_f32_16x16x32_bf16 v[156:159], v[116:119], v[204:207], v[156:159]
    s_add_u32 s32, s32, 16896
    s_cmp_eq_u32 s32, 101376
    s_cselect_b32 s32, 0, s32
    v_add_u32 v249, s32, v250
    v_fma_f32 v184, v184, s35, -v241
    v_fma_f32 v185, v185, s35, -v241
    v_add_f32 v243, v243, v182
    v_add_f32 v243, v243, v183
    v_cvt_pk_bf16_f32 v227, v182, v183
    ds_write_b128 v251, v[224:227] offset:17408
    s_waitcnt lgkmcnt(5)
    v_mfma_f32_16x16x32_bf16 v[128:131], v[24:27], v[208:211], v[128:131]
    v_exp_f32 v184, v184
    v_exp_f32 v185, v185
    v_mfma_f32_16x16x32_bf16 v[132:135], v[56:59], v[208:211], v[132:135]
    v_mfma_f32_16x16x32_bf16 v[136:139], v[88:91], v[208:211], v[136:139]
    v_fma_f32 v186, v186, s35, -v241
    v_fma_f32 v187, v187, s35, -v241
    v_add_f32 v243, v243, v184
    v_add_f32 v243, v243, v185
    v_cvt_pk_bf16_f32 v228, v184, v185
    v_mfma_f32_16x16x32_bf16 v[140:143], v[120:123], v[208:211], v[140:143]
    s_waitcnt lgkmcnt(3)
    v_mfma_f32_16x16x32_bf16 v[144:147], v[24:27], v[212:215], v[144:147]
    v_exp_f32 v186, v186
    v_exp_f32 v187, v187
    v_mfma_f32_16x16x32_bf16 v[148:151], v[56:59], v[212:215], v[148:151]
    v_fma_f32 v188, v188, s35, -v241
    v_fma_f32 v189, v189, s35, -v241
    v_add_f32 v243, v243, v186
    v_add_f32 v243, v243, v187
    v_cvt_pk_bf16_f32 v229, v186, v187
    v_mfma_f32_16x16x32_bf16 v[152:155], v[88:91], v[212:215], v[152:155]
    v_mfma_f32_16x16x32_bf16 v[156:159], v[120:123], v[212:215], v[156:159]
    v_exp_f32 v188, v188
    v_exp_f32 v189, v189
    s_waitcnt lgkmcnt(2)
    v_mfma_f32_16x16x32_bf16 v[128:131], v[28:31], v[216:219], v[128:131]
    v_mfma_f32_16x16x32_bf16 v[132:135], v[60:63], v[216:219], v[132:135]
    v_fma_f32 v190, v190, s35, -v241
    v_fma_f32 v191, v191, s35, -v241
    v_add_f32 v243, v243, v188
    v_add_f32 v243, v243, v189
    v_cvt_pk_bf16_f32 v230, v188, v189
    v_mfma_f32_16x16x32_bf16 v[136:139], v[92:95], v[216:219], v[136:139]
    v_exp_f32 v190, v190
    v_exp_f32 v191, v191
    v_mfma_f32_16x16x32_bf16 v[140:143], v[124:127], v[216:219], v[140:143]
    s_waitcnt lgkmcnt(1)
    v_mfma_f32_16x16x32_bf16 v[144:147], v[28:31], v[220:223], v[144:147]
    v_add_f32 v243, v243, v190
    v_add_f32 v243, v243, v191
    v_cvt_pk_bf16_f32 v231, v190, v191
    ds_write_b128 v251, v[228:231] offset:19456
    v_mfma_f32_16x16x32_bf16 v[148:151], v[60:63], v[220:223], v[148:151]
    v_mfma_f32_16x16x32_bf16 v[152:155], v[92:95], v[220:223], v[152:155]
    v_mfma_f32_16x16x32_bf16 v[156:159], v[124:127], v[220:223], v[156:159]
    v_max3_f32 v244, v128, v129, v130
    v_max3_f32 v245, v144, v145, v146
    v_max3_f32 v244, v244, v131, v132
    s_nop 2
    v_max3_f32 v245, v245, v147, v148
    v_max3_f32 v244, v244, v133, v134
    v_max3_f32 v245, v245, v149, v150
    v_max3_f32 v244, v244, v135, v136
    v_max3_f32 v245, v245, v151, v152
    v_max3_f32 v244, v244, v137, v138
    v_max3_f32 v245, v245, v153, v154
    v_max3_f32 v244, v244, v139, v140
    v_max3_f32 v245, v245, v155, v156
    v_max3_f32 v244, v244, v141, v142
    v_max3_f32 v245, v245, v157, v158
    v_max_f32 v244, v244, v143
    v_max_f32 v245, v245, v159
    s_nop 1
    v_permlane32_swap_b32 v244, v245
    v_permlane32_swap_b32 v242, v243
    v_max_f32 v244, v244, v245
    v_add_f32 v242, v242, v243
    s_nop 1
    v_permlane16_swap_b32 v244, v242
    v_max_f32 v246, v244, v242
    v_add_f32 v247, v244, v242
    v_cndmask_b32 v246, v247, v246, s[40:41]
    ds_write_b32 v252, v246 offset:1024
    s_waitcnt lgkmcnt(0)
    s_barrier
    s_add_u32 s34, s34, 1
    v_subrev_u32 v251, 84480, v251
    ds_read_b128 v[232:235], v253 offset:1024
    ds_read_b128 v[224:227], v253 offset:1280
    s_waitcnt lgkmcnt(1)
    v_max3_f32 v246, v232, v233, v234
    v_max_f32 v246, v246, v235
    v_mul_f32 v240, s35, v246
    s_waitcnt lgkmcnt(0)
    v_max3_f32 v246, v224, v225, v226
    v_max_f32 v246, v246, v227
    v_mul_f32 v241, s35, v246
    v_fma_f32 v128, v128, s35, -v240
    v_fma_f32 v129, v129, s35, -v240
    v_exp_f32 v128, v128
    v_exp_f32 v129, v129
    v_fma_f32 v130, v130, s35, -v240
    v_fma_f32 v131, v131, s35, -v240
    v_add_f32 v242, v128, v129
    v_cvt_pk_bf16_f32 v224, v128, v129
    v_exp_f32 v130, v130
    v_exp_f32 v131, v131
    v_fma_f32 v132, v132, s35, -v240
    v_fma_f32 v133, v133, s35, -v240
    v_add_f32 v242, v242, v130
    v_add_f32 v242, v242, v131
    v_cvt_pk_bf16_f32 v225, v130, v131
    v_exp_f32 v132, v132
    v_exp_f32 v133, v133
    v_fma_f32 v134, v134, s35, -v240
    v_fma_f32 v135, v135, s35, -v240
    v_add_f32 v242, v242, v132
    v_add_f32 v242, v242, v133
    v_cvt_pk_bf16_f32 v226, v132, v133
    v_exp_f32 v134, v134
    v_exp_f32 v135, v135
    v_fma_f32 v136, v136, s35, -v240
    v_fma_f32 v137, v137, s35, -v240
    v_add_f32 v242, v242, v134
    v_add_f32 v242, v242, v135
    v_cvt_pk_bf16_f32 v227, v134, v135
    ds_write_b128 v251, v[224:227]
    v_exp_f32 v136, v136
    v_exp_f32 v137, v137
    v_fma_f32 v138, v138, s35, -v240
    v_fma_f32 v139, v139, s35, -v240
    v_add_f32 v242, v242, v136
    v_add_f32 v242, v242, v137
    v_cvt_pk_bf16_f32 v228, v136, v137
    v_exp_f32 v138, v138
    v_exp_f32 v139, v139
    v_fma_f32 v140, v140, s35, -v240
    v_fma_f32 v141, v141, s35, -v240
    v_add_f32 v242, v242, v138
    v_add_f32 v242, v242, v139
    v_cvt_pk_bf16_f32 v229, v138, v139
    v_exp_f32 v140, v140
    v_exp_f32 v141, v141
    v_fma_f32 v142, v142, s35, -v240
    v_fma_f32 v143, v143, s35, -v240
    v_add_f32 v242, v242, v140
    v_add_f32 v242, v242, v141
    v_cvt_pk_bf16_f32 v230, v140, v141
    v_exp_f32 v142, v142
    v_exp_f32 v143, v143
    v_fma_f32 v144, v144, s35, -v241
    v_fma_f32 v145, v145, s35, -v241
    v_add_f32 v242, v242, v142
    v_add_f32 v242, v242, v143
    v_cvt_pk_bf16_f32 v231, v142, v143
    ds_write_b128 v251, v[228:231] offset:2048
    v_exp_f32 v144, v144
    v_exp_f32 v145, v145
    v_fma_f32 v146, v146, s35, -v241
    v_fma_f32 v147, v147, s35, -v241
    v_add_f32 v243, v144, v145
    v_cvt_pk_bf16_f32 v224, v144, v145
    v_exp_f32 v146, v146
    v_exp_f32 v147, v147
    v_fma_f32 v148, v148, s35, -v241
    v_fma_f32 v149, v149, s35, -v241
    v_add_f32 v243, v243, v146
    v_add_f32 v243, v243, v147
    v_cvt_pk_bf16_f32 v225, v146, v147
    v_exp_f32 v148, v148
    v_exp_f32 v149, v149
    v_fma_f32 v150, v150, s35, -v241
    v_fma_f32 v151, v151, s35, -v241
    v_add_f32 v243, v243, v148
    v_add_f32 v243, v243, v149
    v_cvt_pk_bf16_f32 v226, v148, v149
    v_exp_f32 v150, v150
    v_exp_f32 v151, v151
    v_fma_f32 v152, v152, s35, -v241
    v_fma_f32 v153, v153, s35, -v241
    v_add_f32 v243, v243, v150
    v_add_f32 v243, v243, v151
    v_cvt_pk_bf16_f32 v227, v150, v151
    ds_write_b128 v251, v[224:227] offset:1024
    v_exp_f32 v152, v152
    v_exp_f32 v153, v153
    v_fma_f32 v154, v154, s35, -v241
    v_fma_f32 v155, v155, s35, -v241
    v_add_f32 v243, v243, v152
    v_add_f32 v243, v243, v153
    v_cvt_pk_bf16_f32 v228, v152, v153
    v_exp_f32 v154, v154
    v_exp_f32 v155, v155
    v_fma_f32 v156, v156, s35, -v241
    v_fma_f32 v157, v157, s35, -v241
    v_add_f32 v243, v243, v154
    v_add_f32 v243, v243, v155
    v_cvt_pk_bf16_f32 v229, v154, v155
    v_exp_f32 v156, v156
    v_exp_f32 v157, v157
    v_fma_f32 v158, v158, s35, -v241
    v_fma_f32 v159, v159, s35, -v241
    v_add_f32 v243, v243, v156
    v_add_f32 v243, v243, v157
    v_cvt_pk_bf16_f32 v230, v156, v157
    v_exp_f32 v158, v158
    v_exp_f32 v159, v159
    v_add_f32 v243, v243, v158
    v_add_f32 v243, v243, v159
    v_cvt_pk_bf16_f32 v231, v158, v159
    ds_write_b128 v251, v[228:231] offset:3072
    s_waitcnt lgkmcnt(0)
    s_barrier
    s_barrier
    s_waitcnt lgkmcnt(0)
    ds_read_b128 v[192:195], v249
    ds_read_b128 v[196:199], v249 offset:8448
    ds_read_b128 v[200:203], v249 offset:64
    ds_read_b128 v[204:207], v249 offset:8512
    ds_read_b128 v[208:211], v249 offset:128
    v_add_u32 v251, 84480, v251
    s_waitcnt lgkmcnt(4)
    v_mfma_f32_16x16x32_bf16 v[160:163], v[0:3], v[192:195], 0
    v_mfma_f32_16x16x32_bf16 v[164:167], v[32:35], v[192:195], 0
    v_mfma_f32_16x16x32_bf16 v[168:171], v[64:67], v[192:195], 0
    v_mfma_f32_16x16x32_bf16 v[172:175], v[96:99], v[192:195], 0
    ds_read_b128 v[212:215], v249 offset:8576
    s_waitcnt lgkmcnt(4)
    v_mfma_f32_16x16x32_bf16 v[176:179], v[0:3], v[196:199], 0
    v_mfma_f32_16x16x32_bf16 v[180:183], v[32:35], v[196:199], 0
    v_mfma_f32_16x16x32_bf16 v[184:187], v[64:67], v[196:199], 0
    v_mfma_f32_16x16x32_bf16 v[188:191], v[96:99], v[196:199], 0
    ds_read_b128 v[216:219], v249 offset:192
    s_waitcnt lgkmcnt(4)
    v_mfma_f32_16x16x32_bf16 v[160:163], v[4:7], v[200:203], v[160:163]
    v_mfma_f32_16x16x32_bf16 v[164:167], v[36:39], v[200:203], v[164:167]
    v_mfma_f32_16x16x32_bf16 v[168:171], v[68:71], v[200:203], v[168:171]
    v_mfma_f32_16x16x32_bf16 v[172:175], v[100:103], v[200:203], v[172:175]
    ds_read_b128 v[220:223], v249 offset:8640
    s_waitcnt lgkmcnt(4)
    v_mfma_f32_16x16x32_bf16 v[176:179], v[4:7], v[204:207], v[176:179]
    v_mfma_f32_16x16x32_bf16 v[180:183], v[36:39], v[204:207], v[180:183]
    v_mfma_f32_16x16x32_bf16 v[184:187], v[68:71], v[204:207], v[184:187]
    v_mfma_f32_16x16x32_bf16 v[188:191], v[100:103], v[204:207], v[188:191]
    ds_read_b128 v[192:195], v249 offset:256
    s_waitcnt lgkmcnt(4)
    v_mfma_f32_16x16x32_bf16 v[160:163], v[8:11], v[208:211], v[160:163]
    v_mfma_f32_16x16x32_bf16 v[164:167], v[40:43], v[208:211], v[164:167]
    v_mfma_f32_16x16x32_bf16 v[168:171], v[72:75], v[208:211], v[168:171]
    v_mfma_f32_16x16x32_bf16 v[172:175], v[104:107], v[208:211], v[172:175]
    ds_read_b128 v[196:199], v249 offset:8704
    s_waitcnt lgkmcnt(4)
    v_mfma_f32_16x16x32_bf16 v[176:179], v[8:11], v[212:215], v[176:179]
    v_mfma_f32_16x16x32_bf16 v[180:183], v[40:43], v[212:215], v[180:183]
    v_mfma_f32_16x16x32_bf16 v[184:187], v[72:75], v[212:215], v[184:187]
    v_mfma_f32_16x16x32_bf16 v[188:191], v[104:107], v[212:215], v[188:191]
    ds_read_b128 v[200:203], v249 offset:320
    s_waitcnt lgkmcnt(4)
    v_mfma_f32_16x16x32_bf16 v[160:163], v[12:15], v[216:219], v[160:163]
    v_mfma_f32_16x16x32_bf16 v[164:167], v[44:47], v[216:219], v[164:167]
    v_mfma_f32_16x16x32_bf16 v[168:171], v[76:79], v[216:219], v[168:171]
    v_mfma_f32_16x16x32_bf16 v[172:175], v[108:111], v[216:219], v[172:175]
    ds_read_b128 v[204:207], v249 offset:8768
    s_waitcnt lgkmcnt(4)
    v_mfma_f32_16x16x32_bf16 v[176:179], v[12:15], v[220:223], v[176:179]
    v_mfma_f32_16x16x32_bf16 v[180:183], v[44:47], v[220:223], v[180:183]
    v_mfma_f32_16x16x32_bf16 v[184:187], v[76:79], v[220:223], v[184:187]
    v_mfma_f32_16x16x32_bf16 v[188:191], v[108:111], v[220:223], v[188:191]
    ds_read_b128 v[208:211], v249 offset:384
    s_waitcnt lgkmcnt(4)
    v_mfma_f32_16x16x32_bf16 v[160:163], v[16:19], v[192:195], v[160:163]
    v_mfma_f32_16x16x32_bf16 v[164:167], v[48:51], v[192:195], v[164:167]
    v_mfma_f32_16x16x32_bf16 v[168:171], v[80:83], v[192:195], v[168:171]
    v_mfma_f32_16x16x32_bf16 v[172:175], v[112:115], v[192:195], v[172:175]
    ds_read_b128 v[212:215], v249 offset:8832
    s_waitcnt lgkmcnt(4)
    v_mfma_f32_16x16x32_bf16 v[176:179], v[16:19], v[196:199], v[176:179]
    v_mfma_f32_16x16x32_bf16 v[180:183], v[48:51], v[196:199], v[180:183]
    v_mfma_f32_16x16x32_bf16 v[184:187], v[80:83], v[196:199], v[184:187]
    v_mfma_f32_16x16x32_bf16 v[188:191], v[112:115], v[196:199], v[188:191]
    ds_read_b128 v[216:219], v249 offset:448
    s_waitcnt lgkmcnt(4)
    v_mfma_f32_16x16x32_bf16 v[160:163], v[20:23], v[200:203], v[160:163]
    v_mfma_f32_16x16x32_bf16 v[164:167], v[52:55], v[200:203], v[164:167]
    v_mfma_f32_16x16x32_bf16 v[168:171], v[84:87], v[200:203], v[168:171]
    v_mfma_f32_16x16x32_bf16 v[172:175], v[116:119], v[200:203], v[172:175]
    ds_read_b128 v[220:223], v249 offset:8896
    s_waitcnt lgkmcnt(4)
    v_mfma_f32_16x16x32_bf16 v[176:179], v[20:23], v[204:207], v[176:179]
    v_mfma_f32_16x16x32_bf16 v[180:183], v[52:55], v[204:207], v[180:183]
    v_mfma_f32_16x16x32_bf16 v[184:187], v[84:87], v[204:207], v[184:187]
    v_mfma_f32_16x16x32_bf16 v[188:191], v[116:119], v[204:207], v[188:191]
    s_add_u32 s32, s32, 16896
    s_cmp_eq_u32 s32, 101376
    s_cselect_b32 s32, 0, s32
    v_add_u32 v249, s32, v250
    s_waitcnt lgkmcnt(3)
    v_mfma_f32_16x16x32_bf16 v[160:163], v[24:27], v[208:211], v[160:163]
    v_mfma_f32_16x16x32_bf16 v[164:167], v[56:59], v[208:211], v[164:167]
    v_mfma_f32_16x16x32_bf16 v[168:171], v[88:91], v[208:211], v[168:171]
    v_mfma_f32_16x16x32_bf16 v[172:175], v[120:123], v[208:211], v[172:175]
    s_waitcnt lgkmcnt(2)
    v_mfma_f32_16x16x32_bf16 v[176:179], v[24:27], v[212:215], v[176:179]
    v_mfma_f32_16x16x32_bf16 v[180:183], v[56:59], v[212:215], v[180:183]
    v_mfma_f32_16x16x32_bf16 v[184:187], v[88:91], v[212:215], v[184:187]
    v_mfma_f32_16x16x32_bf16 v[188:191], v[120:123], v[212:215], v[188:191]
    s_waitcnt lgkmcnt(1)
    v_mfma_f32_16x16x32_bf16 v[160:163], v[28:31], v[216:219], v[160:163]
    v_mfma_f32_16x16x32_bf16 v[164:167], v[60:63], v[216:219], v[164:167]
    v_mfma_f32_16x16x32_bf16 v[168:171], v[92:95], v[216:219], v[168:171]
    v_mfma_f32_16x16x32_bf16 v[172:175], v[124:127], v[216:219], v[172:175]
    s_waitcnt lgkmcnt(0)
    v_mfma_f32_16x16x32_bf16 v[176:179], v[28:31], v[220:223], v[176:179]
    v_mfma_f32_16x16x32_bf16 v[180:183], v[60:63], v[220:223], v[180:183]
    v_mfma_f32_16x16x32_bf16 v[184:187], v[92:95], v[220:223], v[184:187]
    v_mfma_f32_16x16x32_bf16 v[188:191], v[124:127], v[220:223], v[188:191]
    v_max3_f32 v244, v160, v161, v162
    s_nop 3
    v_max3_f32 v245, v176, v177, v178
    v_max3_f32 v244, v244, v163, v164
    v_max3_f32 v245, v245, v179, v180
    v_max3_f32 v244, v244, v165, v166
    v_max3_f32 v245, v245, v181, v182
    v_max3_f32 v244, v244, v167, v168
    v_max3_f32 v245, v245, v183, v184
    v_max3_f32 v244, v244, v169, v170
    v_max3_f32 v245, v245, v185, v186
    v_max3_f32 v244, v244, v171, v172
    v_max3_f32 v245, v245, v187, v188
    v_max3_f32 v244, v244, v173, v174
    v_max3_f32 v245, v245, v189, v190
    v_max_f32 v244, v244, v175
    v_max_f32 v245, v245, v191
    s_nop 1
    v_permlane32_swap_b32 v244, v245
    v_permlane32_swap_b32 v242, v243
    v_max_f32 v244, v244, v245
    v_add_f32 v242, v242, v243
    s_nop 1
    v_permlane16_swap_b32 v244, v242
    v_max_f32 v246, v244, v242
    v_add_f32 v247, v244, v242
    v_cndmask_b32 v246, v247, v246, s[40:41]
    ds_write_b32 v252, v246
    s_waitcnt lgkmcnt(0)
    s_barrier
    s_add_u32 s34, s34, 1
    s_waitcnt lgkmcnt(0)
    ds_read_b128 v[192:195], v249
    ds_read_b128 v[196:199], v249 offset:8448
    ds_read_b128 v[200:203], v249 offset:64
    ds_read_b128 v[204:207], v249 offset:8512
    ds_read_b128 v[208:211], v249 offset:128
    s_waitcnt lgkmcnt(4)
    v_mfma_f32_16x16x32_bf16 v[128:131], v[0:3], v[192:195], 0
    v_mfma_f32_16x16x32_bf16 v[132:135], v[32:35], v[192:195], 0
    v_mfma_f32_16x16x32_bf16 v[136:139], v[64:67], v[192:195], 0
    v_mfma_f32_16x16x32_bf16 v[140:143], v[96:99], v[192:195], 0
    ds_read_b128 v[212:215], v249 offset:8576
    s_waitcnt lgkmcnt(4)
    v_mfma_f32_16x16x32_bf16 v[144:147], v[0:3], v[196:199], 0
    v_mfma_f32_16x16x32_bf16 v[148:151], v[32:35], v[196:199], 0
    v_mfma_f32_16x16x32_bf16 v[152:155], v[64:67], v[196:199], 0
    v_mfma_f32_16x16x32_bf16 v[156:159], v[96:99], v[196:199], 0
    ds_read_b128 v[216:219], v249 offset:192
    s_waitcnt lgkmcnt(4)
    v_mfma_f32_16x16x32_bf16 v[128:131], v[4:7], v[200:203], v[128:131]
    v_mfma_f32_16x16x32_bf16 v[132:135], v[36:39], v[200:203], v[132:135]
    v_mfma_f32_16x16x32_bf16 v[136:139], v[68:71], v[200:203], v[136:139]
    v_mfma_f32_16x16x32_bf16 v[140:143], v[100:103], v[200:203], v[140:143]
    ds_read_b128 v[220:223], v249 offset:8640
    s_waitcnt lgkmcnt(4)
    v_mfma_f32_16x16x32_bf16 v[144:147], v[4:7], v[204:207], v[144:147]
    v_mfma_f32_16x16x32_bf16 v[148:151], v[36:39], v[204:207], v[148:151]
    v_mfma_f32_16x16x32_bf16 v[152:155], v[68:71], v[204:207], v[152:155]
    v_mfma_f32_16x16x32_bf16 v[156:159], v[100:103], v[204:207], v[156:159]
    ds_read_b128 v[192:195], v249 offset:256
    s_waitcnt lgkmcnt(4)
    v_mfma_f32_16x16x32_bf16 v[128:131], v[8:11], v[208:211], v[128:131]
    v_mfma_f32_16x16x32_bf16 v[132:135], v[40:43], v[208:211], v[132:135]
    v_mfma_f32_16x16x32_bf16 v[136:139], v[72:75], v[208:211], v[136:139]
    v_mfma_f32_16x16x32_bf16 v[140:143], v[104:107], v[208:211], v[140:143]
    ds_read_b128 v[196:199], v249 offset:8704
    s_waitcnt lgkmcnt(4)
    v_mfma_f32_16x16x32_bf16 v[144:147], v[8:11], v[212:215], v[144:147]
    v_mfma_f32_16x16x32_bf16 v[148:151], v[40:43], v[212:215], v[148:151]
    v_mfma_f32_16x16x32_bf16 v[152:155], v[72:75], v[212:215], v[152:155]
    v_mfma_f32_16x16x32_bf16 v[156:159], v[104:107], v[212:215], v[156:159]
    ds_read_b128 v[200:203], v249 offset:320
    s_waitcnt lgkmcnt(4)
    v_mfma_f32_16x16x32_bf16 v[128:131], v[12:15], v[216:219], v[128:131]
    v_mfma_f32_16x16x32_bf16 v[132:135], v[44:47], v[216:219], v[132:135]
    v_mfma_f32_16x16x32_bf16 v[136:139], v[76:79], v[216:219], v[136:139]
    v_mfma_f32_16x16x32_bf16 v[140:143], v[108:111], v[216:219], v[140:143]
    ds_read_b128 v[204:207], v249 offset:8768
    s_waitcnt lgkmcnt(4)
    v_mfma_f32_16x16x32_bf16 v[144:147], v[12:15], v[220:223], v[144:147]
    v_mfma_f32_16x16x32_bf16 v[148:151], v[44:47], v[220:223], v[148:151]
    v_mfma_f32_16x16x32_bf16 v[152:155], v[76:79], v[220:223], v[152:155]
    v_mfma_f32_16x16x32_bf16 v[156:159], v[108:111], v[220:223], v[156:159]
    ds_read_b128 v[208:211], v249 offset:384
    s_waitcnt lgkmcnt(4)
    v_mfma_f32_16x16x32_bf16 v[128:131], v[16:19], v[192:195], v[128:131]
    v_mfma_f32_16x16x32_bf16 v[132:135], v[48:51], v[192:195], v[132:135]
    v_mfma_f32_16x16x32_bf16 v[136:139], v[80:83], v[192:195], v[136:139]
    v_mfma_f32_16x16x32_bf16 v[140:143], v[112:115], v[192:195], v[140:143]
    ds_read_b128 v[212:215], v249 offset:8832
    s_waitcnt lgkmcnt(4)
    v_mfma_f32_16x16x32_bf16 v[144:147], v[16:19], v[196:199], v[144:147]
    v_mfma_f32_16x16x32_bf16 v[148:151], v[48:51], v[196:199], v[148:151]
    v_mfma_f32_16x16x32_bf16 v[152:155], v[80:83], v[196:199], v[152:155]
    v_mfma_f32_16x16x32_bf16 v[156:159], v[112:115], v[196:199], v[156:159]
    ds_read_b128 v[216:219], v249 offset:448
    s_waitcnt lgkmcnt(4)
    v_mfma_f32_16x16x32_bf16 v[128:131], v[20:23], v[200:203], v[128:131]
    v_mfma_f32_16x16x32_bf16 v[132:135], v[52:55], v[200:203], v[132:135]
    v_mfma_f32_16x16x32_bf16 v[136:139], v[84:87], v[200:203], v[136:139]
    v_mfma_f32_16x16x32_bf16 v[140:143], v[116:119], v[200:203], v[140:143]
    ds_read_b128 v[220:223], v249 offset:8896
    s_waitcnt lgkmcnt(4)
    v_mfma_f32_16x16x32_bf16 v[144:147], v[20:23], v[204:207], v[144:147]
    v_mfma_f32_16x16x32_bf16 v[148:151], v[52:55], v[204:207], v[148:151]
    v_mfma_f32_16x16x32_bf16 v[152:155], v[84:87], v[204:207], v[152:155]
    v_mfma_f32_16x16x32_bf16 v[156:159], v[116:119], v[204:207], v[156:159]
    s_add_u32 s32, s32, 16896
    s_cmp_eq_u32 s32, 101376
    s_cselect_b32 s32, 0, s32
    v_add_u32 v249, s32, v250
    s_waitcnt lgkmcnt(3)
    v_mfma_f32_16x16x32_bf16 v[128:131], v[24:27], v[208:211], v[128:131]
    v_mfma_f32_16x16x32_bf16 v[132:135], v[56:59], v[208:211], v[132:135]
    v_mfma_f32_16x16x32_bf16 v[136:139], v[88:91], v[208:211], v[136:139]
    v_mfma_f32_16x16x32_bf16 v[140:143], v[120:123], v[208:211], v[140:143]
    s_waitcnt lgkmcnt(2)
    v_mfma_f32_16x16x32_bf16 v[144:147], v[24:27], v[212:215], v[144:147]
    v_mfma_f32_16x16x32_bf16 v[148:151], v[56:59], v[212:215], v[148:151]
    v_mfma_f32_16x16x32_bf16 v[152:155], v[88:91], v[212:215], v[152:155]
    v_mfma_f32_16x16x32_bf16 v[156:159], v[120:123], v[212:215], v[156:159]
    s_waitcnt lgkmcnt(1)
    v_mfma_f32_16x16x32_bf16 v[128:131], v[28:31], v[216:219], v[128:131]
    v_mfma_f32_16x16x32_bf16 v[132:135], v[60:63], v[216:219], v[132:135]
    v_mfma_f32_16x16x32_bf16 v[136:139], v[92:95], v[216:219], v[136:139]
    v_mfma_f32_16x16x32_bf16 v[140:143], v[124:127], v[216:219], v[140:143]
    s_waitcnt lgkmcnt(0)
    v_mfma_f32_16x16x32_bf16 v[144:147], v[28:31], v[220:223], v[144:147]
    v_mfma_f32_16x16x32_bf16 v[148:151], v[60:63], v[220:223], v[148:151]
    v_mfma_f32_16x16x32_bf16 v[152:155], v[92:95], v[220:223], v[152:155]
    v_mfma_f32_16x16x32_bf16 v[156:159], v[124:127], v[220:223], v[156:159]
    v_max3_f32 v244, v128, v129, v130
    s_nop 3
    v_max3_f32 v245, v144, v145, v146
    v_max3_f32 v244, v244, v131, v132
    v_max3_f32 v245, v245, v147, v148
    v_max3_f32 v244, v244, v133, v134
    v_max3_f32 v245, v245, v149, v150
    v_max3_f32 v244, v244, v135, v136
    v_max3_f32 v245, v245, v151, v152
    v_max3_f32 v244, v244, v137, v138
    v_max3_f32 v245, v245, v153, v154
    v_max3_f32 v244, v244, v139, v140
    v_max3_f32 v245, v245, v155, v156
    v_max3_f32 v244, v244, v141, v142
    v_max3_f32 v245, v245, v157, v158
    v_max_f32 v244, v244, v143
    v_max_f32 v245, v245, v159
    s_barrier
    ds_read_b128 v[232:235], v253
    ds_read_b128 v[224:227], v253 offset:256
    s_waitcnt lgkmcnt(1)
    v_max3_f32 v246, v232, v233, v234
    v_max_f32 v246, v246, v235
    v_mul_f32 v240, s35, v246
    s_waitcnt lgkmcnt(0)
    v_max3_f32 v246, v224, v225, v226
    v_max_f32 v246, v246, v227
    v_mul_f32 v241, s35, v246
    v_fma_f32 v160, v160, s35, -v240
    v_fma_f32 v161, v161, s35, -v240
    v_exp_f32 v160, v160
    v_exp_f32 v161, v161
    v_fma_f32 v162, v162, s35, -v240
    v_fma_f32 v163, v163, s35, -v240
    v_add_f32 v242, v160, v161
    v_cvt_pk_bf16_f32 v224, v160, v161
    v_exp_f32 v162, v162
    v_exp_f32 v163, v163
    v_fma_f32 v164, v164, s35, -v240
    v_fma_f32 v165, v165, s35, -v240
    v_add_f32 v242, v242, v162
    v_add_f32 v242, v242, v163
    v_cvt_pk_bf16_f32 v225, v162, v163
    v_exp_f32 v164, v164
    v_exp_f32 v165, v165
    v_fma_f32 v166, v166, s35, -v240
    v_fma_f32 v167, v167, s35, -v240
    v_add_f32 v242, v242, v164
    v_add_f32 v242, v242, v165
    v_cvt_pk_bf16_f32 v226, v164, v165
    v_exp_f32 v166, v166
    v_exp_f32 v167, v167
    v_fma_f32 v168, v168, s35, -v240
    v_fma_f32 v169, v169, s35, -v240
    v_add_f32 v242, v242, v166
    v_add_f32 v242, v242, v167
    v_cvt_pk_bf16_f32 v227, v166, v167
    ds_write_b128 v251, v[224:227] offset:16384
    v_exp_f32 v168, v168
    v_exp_f32 v169, v169
    v_fma_f32 v170, v170, s35, -v240
    v_fma_f32 v171, v171, s35, -v240
    v_add_f32 v242, v242, v168
    v_add_f32 v242, v242, v169
    v_cvt_pk_bf16_f32 v228, v168, v169
    v_exp_f32 v170, v170
    v_exp_f32 v171, v171
    v_fma_f32 v172, v172, s35, -v240
    v_fma_f32 v173, v173, s35, -v240
    v_add_f32 v242, v242, v170
    v_add_f32 v242, v242, v171
    v_cvt_pk_bf16_f32 v229, v170, v171
    v_exp_f32 v172, v172
    v_exp_f32 v173, v173
    v_fma_f32 v174, v174, s35, -v240
    v_fma_f32 v175, v175, s35, -v240
    v_add_f32 v242, v242, v172
    v_add_f32 v242, v242, v173
    v_cvt_pk_bf16_f32 v230, v172, v173
    v_exp_f32 v174, v174
    v_exp_f32 v175, v175
    v_fma_f32 v176, v176, s35, -v241
    v_fma_f32 v177, v177, s35, -v241
    v_add_f32 v242, v242, v174
    v_add_f32 v242, v242, v175
    v_cvt_pk_bf16_f32 v231, v174, v175
    ds_write_b128 v251, v[228:231] offset:18432
    v_exp_f32 v176, v176
    v_exp_f32 v177, v177
    v_fma_f32 v178, v178, s35, -v241
    v_fma_f32 v179, v179, s35, -v241
    v_add_f32 v243, v176, v177
    v_cvt_pk_bf16_f32 v224, v176, v177
    v_exp_f32 v178, v178
    v_exp_f32 v179, v179
    v_fma_f32 v180, v180, s35, -v241
    v_fma_f32 v181, v181, s35, -v241
    v_add_f32 v243, v243, v178
    v_add_f32 v243, v243, v179
    v_cvt_pk_bf16_f32 v225, v178, v179
    v_exp_f32 v180, v180
    v_exp_f32 v181, v181
    v_fma_f32 v182, v182, s35, -v241
    v_fma_f32 v183, v183, s35, -v241
    v_add_f32 v243, v243, v180
    v_add_f32 v243, v243, v181
    v_cvt_pk_bf16_f32 v226, v180, v181
    v_exp_f32 v182, v182
    v_exp_f32 v183, v183
    v_fma_f32 v184, v184, s35, -v241
    v_fma_f32 v185, v185, s35, -v241
    v_add_f32 v243, v243, v182
    v_add_f32 v243, v243, v183
    v_cvt_pk_bf16_f32 v227, v182, v183
    ds_write_b128 v251, v[224:227] offset:17408
    v_exp_f32 v184, v184
    v_exp_f32 v185, v185
    v_fma_f32 v186, v186, s35, -v241
    v_fma_f32 v187, v187, s35, -v241
    v_add_f32 v243, v243, v184
    v_add_f32 v243, v243, v185
    v_cvt_pk_bf16_f32 v228, v184, v185
    v_exp_f32 v186, v186
    v_exp_f32 v187, v187
    v_fma_f32 v188, v188, s35, -v241
    v_fma_f32 v189, v189, s35, -v241
    v_add_f32 v243, v243, v186
    v_add_f32 v243, v243, v187
    v_cvt_pk_bf16_f32 v229, v186, v187
    v_exp_f32 v188, v188
    v_exp_f32 v189, v189
    v_fma_f32 v190, v190, s35, -v241
    v_fma_f32 v191, v191, s35, -v241
    v_add_f32 v243, v243, v188
    v_add_f32 v243, v243, v189
    v_cvt_pk_bf16_f32 v230, v188, v189
    v_exp_f32 v190, v190
    v_exp_f32 v191, v191
    v_add_f32 v243, v243, v190
    v_add_f32 v243, v243, v191
    v_cvt_pk_bf16_f32 v231, v190, v191
    ds_write_b128 v251, v[228:231] offset:19456
    v_permlane32_swap_b32 v244, v245
    v_permlane32_swap_b32 v242, v243
    v_max_f32 v244, v244, v245
    v_add_f32 v242, v242, v243
    s_nop 1
    v_permlane16_swap_b32 v244, v242
    v_max_f32 v246, v244, v242
    v_add_f32 v247, v244, v242
    v_cndmask_b32 v246, v247, v246, s[40:41]
    ds_write_b32 v252, v246 offset:1024
    s_waitcnt lgkmcnt(0)
    s_barrier
    s_waitcnt lgkmcnt(0)
    ds_read_b128 v[192:195], v249
    ds_read_b128 v[196:199], v249 offset:8448
    ds_read_b128 v[200:203], v249 offset:64
    ds_read_b128 v[204:207], v249 offset:8512
    ds_read_b128 v[208:211], v249 offset:128
    s_add_u32 s34, s34, 1
.p2align 6
L_qk_loop:
    ds_read_b128 v[232:235], v253 offset:1024
    ds_read_b128 v[224:227], v253 offset:1280
    s_waitcnt lgkmcnt(6)
    v_mfma_f32_16x16x32_bf16 v[160:163], v[0:3], v[192:195], 0
    v_mfma_f32_16x16x32_bf16 v[164:167], v[32:35], v[192:195], 0
    v_mfma_f32_16x16x32_bf16 v[168:171], v[64:67], v[192:195], 0
    v_mfma_f32_16x16x32_bf16 v[172:175], v[96:99], v[192:195], 0
    ds_read_b128 v[212:215], v249 offset:8576
    s_waitcnt lgkmcnt(6)
    v_mfma_f32_16x16x32_bf16 v[176:179], v[0:3], v[196:199], 0
    v_mfma_f32_16x16x32_bf16 v[180:183], v[32:35], v[196:199], 0
    v_mfma_f32_16x16x32_bf16 v[184:187], v[64:67], v[196:199], 0
    v_mfma_f32_16x16x32_bf16 v[188:191], v[96:99], v[196:199], 0
    ds_read_b128 v[216:219], v249 offset:192
    s_waitcnt lgkmcnt(3)
    v_max3_f32 v246, v232, v233, v234
    v_max_f32 v246, v246, v235
    v_mul_f32 v240, s35, v246
    s_waitcnt lgkmcnt(2)
    v_max3_f32 v246, v224, v225, v226
    v_max_f32 v246, v246, v227
    v_mul_f32 v241, s35, v246
    v_mfma_f32_16x16x32_bf16 v[160:163], v[4:7], v[200:203], v[160:163]
    v_fma_f32 v128, v128, s35, -v240
    v_fma_f32 v129, v129, s35, -v240
    v_mfma_f32_16x16x32_bf16 v[164:167], v[36:39], v[200:203], v[164:167]
    v_mfma_f32_16x16x32_bf16 v[168:171], v[68:71], v[200:203], v[168:171]
    v_mfma_f32_16x16x32_bf16 v[172:175], v[100:103], v[200:203], v[172:175]
    ds_read_b128 v[220:223], v249 offset:8640
    v_mfma_f32_16x16x32_bf16 v[176:179], v[4:7], v[204:207], v[176:179]
    v_mfma_f32_16x16x32_bf16 v[180:183], v[36:39], v[204:207], v[180:183]
    v_mfma_f32_16x16x32_bf16 v[184:187], v[68:71], v[204:207], v[184:187]
    v_exp_f32 v128, v128
    v_exp_f32 v129, v129
    v_mfma_f32_16x16x32_bf16 v[188:191], v[100:103], v[204:207], v[188:191]
    ds_read_b128 v[192:195], v249 offset:256
    v_mfma_f32_16x16x32_bf16 v[160:163], v[8:11], v[208:211], v[160:163]
    v_mfma_f32_16x16x32_bf16 v[164:167], v[40:43], v[208:211], v[164:167]
    v_mfma_f32_16x16x32_bf16 v[168:171], v[72:75], v[208:211], v[168:171]
    v_mfma_f32_16x16x32_bf16 v[172:175], v[104:107], v[208:211], v[172:175]
    ds_read_b128 v[196:199], v249 offset:8704
    s_waitcnt lgkmcnt(4)
    v_mfma_f32_16x16x32_bf16 v[176:179], v[8:11], v[212:215], v[176:179]
    v_mfma_f32_16x16x32_bf16 v[180:183], v[40:43], v[212:215], v[180:183]
    v_fma_f32 v130, v130, s35, -v240
    v_fma_f32 v131, v131, s35, -v240
    v_add_f32 v242, v128, v129
    v_cvt_pk_bf16_f32 v224, v128, v129
    v_mfma_f32_16x16x32_bf16 v[184:187], v[72:75], v[212:215], v[184:187]
    v_mfma_f32_16x16x32_bf16 v[188:191], v[104:107], v[212:215], v[188:191]
    ds_read_b128 v[200:203], v249 offset:320
    s_waitcnt lgkmcnt(4)
    v_mfma_f32_16x16x32_bf16 v[160:163], v[12:15], v[216:219], v[160:163]
    v_mfma_f32_16x16x32_bf16 v[164:167], v[44:47], v[216:219], v[164:167]
    v_mfma_f32_16x16x32_bf16 v[168:171], v[76:79], v[216:219], v[168:171]
    v_mfma_f32_16x16x32_bf16 v[172:175], v[108:111], v[216:219], v[172:175]
    ds_read_b128 v[204:207], v249 offset:8768
    s_waitcnt lgkmcnt(4)
    v_mfma_f32_16x16x32_bf16 v[176:179], v[12:15], v[220:223], v[176:179]
    v_exp_f32 v130, v130
    v_exp_f32 v131, v131
    v_mfma_f32_16x16x32_bf16 v[180:183], v[44:47], v[220:223], v[180:183]
    v_mfma_f32_16x16x32_bf16 v[184:187], v[76:79], v[220:223], v[184:187]
    v_mfma_f32_16x16x32_bf16 v[188:191], v[108:111], v[220:223], v[188:191]
    ds_read_b128 v[208:211], v249 offset:384
    s_waitcnt lgkmcnt(4)
    v_mfma_f32_16x16x32_bf16 v[160:163], v[16:19], v[192:195], v[160:163]
    v_mfma_f32_16x16x32_bf16 v[164:167], v[48:51], v[192:195], v[164:167]
    v_mfma_f32_16x16x32_bf16 v[168:171], v[80:83], v[192:195], v[168:171]
    v_mfma_f32_16x16x32_bf16 v[172:175], v[112:115], v[192:195], v[172:175]
    ds_read_b128 v[212:215], v249 offset:8832
    v_fma_f32 v132, v132, s35, -v240
    v_fma_f32 v133, v133, s35, -v240
    v_add_f32 v242, v242, v130
    v_add_f32 v242, v242, v131
    v_cvt_pk_bf16_f32 v225, v130, v131
    s_waitcnt lgkmcnt(4)
    v_mfma_f32_16x16x32_bf16 v[176:179], v[16:19], v[196:199], v[176:179]
    v_mfma_f32_16x16x32_bf16 v[180:183], v[48:51], v[196:199], v[180:183]
    v_mfma_f32_16x16x32_bf16 v[184:187], v[80:83], v[196:199], v[184:187]
    v_mfma_f32_16x16x32_bf16 v[188:191], v[112:115], v[196:199], v[188:191]
    ds_read_b128 v[216:219], v249 offset:448
    s_waitcnt lgkmcnt(4)
    v_mfma_f32_16x16x32_bf16 v[160:163], v[20:23], v[200:203], v[160:163]
    v_mfma_f32_16x16x32_bf16 v[164:167], v[52:55], v[200:203], v[164:167]
    v_exp_f32 v132, v132
    v_exp_f32 v133, v133
    v_mfma_f32_16x16x32_bf16 v[168:171], v[84:87], v[200:203], v[168:171]
    v_mfma_f32_16x16x32_bf16 v[172:175], v[116:119], v[200:203], v[172:175]
    ds_read_b128 v[220:223], v249 offset:8896
    s_waitcnt lgkmcnt(4)
    v_mfma_f32_16x16x32_bf16 v[176:179], v[20:23], v[204:207], v[176:179]
    v_mfma_f32_16x16x32_bf16 v[180:183], v[52:55], v[204:207], v[180:183]
    v_mfma_f32_16x16x32_bf16 v[184:187], v[84:87], v[204:207], v[184:187]
    v_mfma_f32_16x16x32_bf16 v[188:191], v[116:119], v[204:207], v[188:191]
    s_add_u32 s32, s32, 16896
    s_cmp_eq_u32 s32, 101376
    s_cselect_b32 s32, 0, s32
    v_add_u32 v249, s32, v250
    ds_read_b128 v[192:195], v249
    s_waitcnt lgkmcnt(4)
    v_mfma_f32_16x16x32_bf16 v[160:163], v[24:27], v[208:211], v[160:163]
    v_fma_f32 v134, v134, s35, -v240
    v_fma_f32 v135, v135, s35, -v240
    v_add_f32 v242, v242, v132
    v_add_f32 v242, v242, v133
    v_cvt_pk_bf16_f32 v226, v132, v133
    v_mfma_f32_16x16x32_bf16 v[164:167], v[56:59], v[208:211], v[164:167]
    v_mfma_f32_16x16x32_bf16 v[168:171], v[88:91], v[208:211], v[168:171]
    v_mfma_f32_16x16x32_bf16 v[172:175], v[120:123], v[208:211], v[172:175]
    ds_read_b128 v[196:199], v249 offset:8448
    s_waitcnt lgkmcnt(4)
    v_mfma_f32_16x16x32_bf16 v[176:179], v[24:27], v[212:215], v[176:179]
    v_mfma_f32_16x16x32_bf16 v[180:183], v[56:59], v[212:215], v[180:183]
    v_mfma_f32_16x16x32_bf16 v[184:187], v[88:91], v[212:215], v[184:187]
    v_mfma_f32_16x16x32_bf16 v[188:191], v[120:123], v[212:215], v[188:191]
    ds_read_b128 v[200:203], v249 offset:64
    v_exp_f32 v134, v134
    v_exp_f32 v135, v135
    s_waitcnt lgkmcnt(4)
    v_mfma_f32_16x16x32_bf16 v[160:163], v[28:31], v[216:219], v[160:163]
    v_mfma_f32_16x16x32_bf16 v[164:167], v[60:63], v[216:219], v[164:167]
    v_mfma_f32_16x16x32_bf16 v[168:171], v[92:95], v[216:219], v[168:171]
    v_mfma_f32_16x16x32_bf16 v[172:175], v[124:127], v[216:219], v[172:175]
    ds_read_b128 v[204:207], v249 offset:8512
    s_waitcnt lgkmcnt(4)
    v_mfma_f32_16x16x32_bf16 v[176:179], v[28:31], v[220:223], v[176:179]
    v_mfma_f32_16x16x32_bf16 v[180:183], v[60:63], v[220:223], v[180:183]
    v_mfma_f32_16x16x32_bf16 v[184:187], v[92:95], v[220:223], v[184:187]
    v_mfma_f32_16x16x32_bf16 v[188:191], v[124:127], v[220:223], v[188:191]
    ds_read_b128 v[208:211], v249 offset:128
    v_fma_f32 v136, v136, s35, -v240
    v_fma_f32 v137, v137, s35, -v240
    v_add_f32 v242, v242, v134
    v_add_f32 v242, v242, v135
    v_cvt_pk_bf16_f32 v227, v134, v135
    ds_write_b128 v251, v[224:227]
    v_exp_f32 v136, v136
    v_exp_f32 v137, v137
    v_fma_f32 v138, v138, s35, -v240
    v_fma_f32 v139, v139, s35, -v240
    v_add_f32 v242, v242, v136
    v_add_f32 v242, v242, v137
    v_cvt_pk_bf16_f32 v228, v136, v137
    v_exp_f32 v138, v138
    v_exp_f32 v139, v139
    v_fma_f32 v140, v140, s35, -v240
    v_fma_f32 v141, v141, s35, -v240
    v_max3_f32 v244, v160, v161, v162
    v_add_f32 v242, v242, v138
    v_add_f32 v242, v242, v139
    v_cvt_pk_bf16_f32 v229, v138, v139
    v_max3_f32 v245, v176, v177, v178
    v_exp_f32 v140, v140
    v_exp_f32 v141, v141
    v_fma_f32 v142, v142, s35, -v240
    v_max3_f32 v244, v244, v163, v164
    v_fma_f32 v143, v143, s35, -v240
    v_add_f32 v242, v242, v140
    v_add_f32 v242, v242, v141
    v_max3_f32 v245, v245, v179, v180
    v_cvt_pk_bf16_f32 v230, v140, v141
    v_exp_f32 v142, v142
    v_exp_f32 v143, v143
    v_max3_f32 v244, v244, v165, v166
    v_fma_f32 v144, v144, s35, -v241
    v_fma_f32 v145, v145, s35, -v241
    v_add_f32 v242, v242, v142
    v_max3_f32 v245, v245, v181, v182
    v_add_f32 v242, v242, v143
    v_cvt_pk_bf16_f32 v231, v142, v143
    ds_write_b128 v251, v[228:231] offset:2048
    v_max3_f32 v244, v244, v167, v168
    v_exp_f32 v144, v144
    v_exp_f32 v145, v145
    v_fma_f32 v146, v146, s35, -v241
    v_max3_f32 v245, v245, v183, v184
    v_fma_f32 v147, v147, s35, -v241
    v_add_f32 v243, v144, v145
    v_cvt_pk_bf16_f32 v224, v144, v145
    v_max3_f32 v244, v244, v169, v170
    v_exp_f32 v146, v146
    v_exp_f32 v147, v147
    v_fma_f32 v148, v148, s35, -v241
    v_max3_f32 v245, v245, v185, v186
    v_fma_f32 v149, v149, s35, -v241
    v_add_f32 v243, v243, v146
    v_add_f32 v243, v243, v147
    v_max3_f32 v244, v244, v171, v172
    v_cvt_pk_bf16_f32 v225, v146, v147
    v_exp_f32 v148, v148
    v_exp_f32 v149, v149
    v_max3_f32 v245, v245, v187, v188
    v_fma_f32 v150, v150, s35, -v241
    v_fma_f32 v151, v151, s35, -v241
    v_add_f32 v243, v243, v148
    v_max3_f32 v244, v244, v173, v174
    v_add_f32 v243, v243, v149
    v_cvt_pk_bf16_f32 v226, v148, v149
    v_exp_f32 v150, v150
    v_max3_f32 v245, v245, v189, v190
    v_exp_f32 v151, v151
    v_fma_f32 v152, v152, s35, -v241
    v_fma_f32 v153, v153, s35, -v241
    v_max_f32 v244, v244, v175
    v_add_f32 v243, v243, v150
    v_add_f32 v243, v243, v151
    v_cvt_pk_bf16_f32 v227, v150, v151
    v_max_f32 v245, v245, v191
    ds_write_b128 v251, v[224:227] offset:1024
    v_exp_f32 v152, v152
    v_exp_f32 v153, v153
    v_fma_f32 v154, v154, s35, -v241
    v_fma_f32 v155, v155, s35, -v241
    v_add_f32 v243, v243, v152
    v_add_f32 v243, v243, v153
    v_cvt_pk_bf16_f32 v228, v152, v153
    v_exp_f32 v154, v154
    v_exp_f32 v155, v155
    v_fma_f32 v156, v156, s35, -v241
    v_fma_f32 v157, v157, s35, -v241
    v_add_f32 v243, v243, v154
    v_add_f32 v243, v243, v155
    v_cvt_pk_bf16_f32 v229, v154, v155
    v_exp_f32 v156, v156
    v_exp_f32 v157, v157
    v_fma_f32 v158, v158, s35, -v241
    v_fma_f32 v159, v159, s35, -v241
    v_add_f32 v243, v243, v156
    v_add_f32 v243, v243, v157
    v_cvt_pk_bf16_f32 v230, v156, v157
    v_exp_f32 v158, v158
    v_exp_f32 v159, v159
    v_add_f32 v243, v243, v158
    v_add_f32 v243, v243, v159
    v_cvt_pk_bf16_f32 v231, v158, v159
    ds_write_b128 v251, v[228:231] offset:3072
    v_permlane32_swap_b32 v244, v245
    v_permlane32_swap_b32 v242, v243
    v_max_f32 v244, v244, v245
    v_add_f32 v242, v242, v243
    s_nop 1
    v_permlane16_swap_b32 v244, v242
    v_max_f32 v246, v244, v242
    v_add_f32 v247, v244, v242
    v_cndmask_b32 v246, v247, v246, s[40:41]
    ds_write_b32 v252, v246
    s_waitcnt lgkmcnt(0)
    s_barrier
    s_cmp_eq_u32 s34, 15
    s_cbranch_scc1 L_qk_tail
    s_cmp_lg_u32 s34, 5
    s_cbranch_scc1 L_qk_r0
    s_waitcnt lgkmcnt(0)
    ds_read_b128 v[192:195], v249
    ds_read_b128 v[196:199], v249 offset:8448
    ds_read_b128 v[200:203], v249 offset:64
    ds_read_b128 v[204:207], v249 offset:8512
    ds_read_b128 v[208:211], v249 offset:128
    s_waitcnt lgkmcnt(0)
L_qk_r0:
    s_add_u32 s34, s34, 1
    ds_read_b128 v[232:235], v253
    ds_read_b128 v[224:227], v253 offset:256
    v_mfma_f32_16x16x32_bf16 v[128:131], v[0:3], v[192:195], 0
    v_mfma_f32_16x16x32_bf16 v[132:135], v[32:35], v[192:195], 0
    v_mfma_f32_16x16x32_bf16 v[136:139], v[64:67], v[192:195], 0
    v_mfma_f32_16x16x32_bf16 v[140:143], v[96:99], v[192:195], 0
    ds_read_b128 v[212:215], v249 offset:8576
    v_mfma_f32_16x16x32_bf16 v[144:147], v[0:3], v[196:199], 0
    v_mfma_f32_16x16x32_bf16 v[148:151], v[32:35], v[196:199], 0
    v_mfma_f32_16x16x32_bf16 v[152:155], v[64:67], v[196:199], 0
    v_mfma_f32_16x16x32_bf16 v[156:159], v[96:99], v[196:199], 0
    ds_read_b128 v[216:219], v249 offset:192
    s_waitcnt lgkmcnt(3)
    v_max3_f32 v246, v232, v233, v234
    v_max_f32 v246, v246, v235
    v_mul_f32 v240, s35, v246
    s_waitcnt lgkmcnt(2)
    v_max3_f32 v246, v224, v225, v226
    v_max_f32 v246, v246, v227
    v_mul_f32 v241, s35, v246
    v_mfma_f32_16x16x32_bf16 v[128:131], v[4:7], v[200:203], v[128:131]
    v_fma_f32 v160, v160, s35, -v240
    v_fma_f32 v161, v161, s35, -v240
    v_mfma_f32_16x16x32_bf16 v[132:135], v[36:39], v[200:203], v[132:135]
    v_mfma_f32_16x16x32_bf16 v[136:139], v[68:71], v[200:203], v[136:139]
    v_mfma_f32_16x16x32_bf16 v[140:143], v[100:103], v[200:203], v[140:143]
    ds_read_b128 v[220:223], v249 offset:8640
    v_mfma_f32_16x16x32_bf16 v[144:147], v[4:7], v[204:207], v[144:147]
    v_mfma_f32_16x16x32_bf16 v[148:151], v[36:39], v[204:207], v[148:151]
    v_mfma_f32_16x16x32_bf16 v[152:155], v[68:71], v[204:207], v[152:155]
    v_exp_f32 v160, v160
    v_exp_f32 v161, v161
    v_mfma_f32_16x16x32_bf16 v[156:159], v[100:103], v[204:207], v[156:159]
    ds_read_b128 v[192:195], v249 offset:256
    v_mfma_f32_16x16x32_bf16 v[128:131], v[8:11], v[208:211], v[128:131]
    v_mfma_f32_16x16x32_bf16 v[132:135], v[40:43], v[208:211], v[132:135]
    v_mfma_f32_16x16x32_bf16 v[136:139], v[72:75], v[208:211], v[136:139]
    v_mfma_f32_16x16x32_bf16 v[140:143], v[104:107], v[208:211], v[140:143]
    ds_read_b128 v[196:199], v249 offset:8704
    s_waitcnt lgkmcnt(4)
    v_mfma_f32_16x16x32_bf16 v[144:147], v[8:11], v[212:215], v[144:147]
    v_mfma_f32_16x16x32_bf16 v[148:151], v[40:43], v[212:215], v[148:151]
    v_fma_f32 v162, v162, s35, -v240
    v_fma_f32 v163, v163, s35, -v240
    v_add_f32 v242, v160, v161
    v_cvt_pk_bf16_f32 v224, v160, v161
    v_mfma_f32_16x16x32_bf16 v[152:155], v[72:75], v[212:215], v[152:155]
    v_mfma_f32_16x16x32_bf16 v[156:159], v[104:107], v[212:215], v[156:159]
    ds_read_b128 v[200:203], v249 offset:320
    s_waitcnt lgkmcnt(4)
    v_mfma_f32_16x16x32_bf16 v[128:131], v[12:15], v[216:219], v[128:131]
    v_mfma_f32_16x16x32_bf16 v[132:135], v[44:47], v[216:219], v[132:135]
    v_mfma_f32_16x16x32_bf16 v[136:139], v[76:79], v[216:219], v[136:139]
    v_mfma_f32_16x16x32_bf16 v[140:143], v[108:111], v[216:219], v[140:143]
    ds_read_b128 v[204:207], v249 offset:8768
    s_waitcnt lgkmcnt(4)
    v_mfma_f32_16x16x32_bf16 v[144:147], v[12:15], v[220:223], v[144:147]
    v_exp_f32 v162, v162
    v_exp_f32 v163, v163
    v_mfma_f32_16x16x32_bf16 v[148:151], v[44:47], v[220:223], v[148:151]
    v_mfma_f32_16x16x32_bf16 v[152:155], v[76:79], v[220:223], v[152:155]
    v_mfma_f32_16x16x32_bf16 v[156:159], v[108:111], v[220:223], v[156:159]
    ds_read_b128 v[208:211], v249 offset:384
    s_waitcnt lgkmcnt(4)
    v_mfma_f32_16x16x32_bf16 v[128:131], v[16:19], v[192:195], v[128:131]
    v_mfma_f32_16x16x32_bf16 v[132:135], v[48:51], v[192:195], v[132:135]
    v_mfma_f32_16x16x32_bf16 v[136:139], v[80:83], v[192:195], v[136:139]
    v_mfma_f32_16x16x32_bf16 v[140:143], v[112:115], v[192:195], v[140:143]
    ds_read_b128 v[212:215], v249 offset:8832
    v_fma_f32 v164, v164, s35, -v240
    v_fma_f32 v165, v165, s35, -v240
    v_add_f32 v242, v242, v162
    v_add_f32 v242, v242, v163
    v_cvt_pk_bf16_f32 v225, v162, v163
    s_waitcnt lgkmcnt(4)
    v_mfma_f32_16x16x32_bf16 v[144:147], v[16:19], v[196:199], v[144:147]
    v_mfma_f32_16x16x32_bf16 v[148:151], v[48:51], v[196:199], v[148:151]
    v_mfma_f32_16x16x32_bf16 v[152:155], v[80:83], v[196:199], v[152:155]
    v_mfma_f32_16x16x32_bf16 v[156:159], v[112:115], v[196:199], v[156:159]
    ds_read_b128 v[216:219], v249 offset:448
    s_waitcnt lgkmcnt(4)
    v_mfma_f32_16x16x32_bf16 v[128:131], v[20:23], v[200:203], v[128:131]
    v_mfma_f32_16x16x32_bf16 v[132:135], v[52:55], v[200:203], v[132:135]
    v_exp_f32 v164, v164
    v_exp_f32 v165, v165
    v_mfma_f32_16x16x32_bf16 v[136:139], v[84:87], v[200:203], v[136:139]
    v_mfma_f32_16x16x32_bf16 v[140:143], v[116:119], v[200:203], v[140:143]
    ds_read_b128 v[220:223], v249 offset:8896
    s_waitcnt lgkmcnt(4)
    v_mfma_f32_16x16x32_bf16 v[144:147], v[20:23], v[204:207], v[144:147]
    v_mfma_f32_16x16x32_bf16 v[148:151], v[52:55], v[204:207], v[148:151]
    v_mfma_f32_16x16x32_bf16 v[152:155], v[84:87], v[204:207], v[152:155]
    v_mfma_f32_16x16x32_bf16 v[156:159], v[116:119], v[204:207], v[156:159]
    s_add_u32 s32, s32, 16896
    s_cmp_eq_u32 s32, 101376
    s_cselect_b32 s32, 0, s32
    v_add_u32 v249, s32, v250
    ds_read_b128 v[192:195], v249
    s_waitcnt lgkmcnt(4)
    v_mfma_f32_16x16x32_bf16 v[128:131], v[24:27], v[208:211], v[128:131]
    v_fma_f32 v166, v166, s35, -v240
    v_fma_f32 v167, v167, s35, -v240
    v_add_f32 v242, v242, v164
    v_add_f32 v242, v242, v165
    v_cvt_pk_bf16_f32 v226, v164, v165
    v_mfma_f32_16x16x32_bf16 v[132:135], v[56:59], v[208:211], v[132:135]
    v_mfma_f32_16x16x32_bf16 v[136:139], v[88:91], v[208:211], v[136:139]
    v_mfma_f32_16x16x32_bf16 v[140:143], v[120:123], v[208:211], v[140:143]
    ds_read_b128 v[196:199], v249 offset:8448
    s_waitcnt lgkmcnt(4)
    v_mfma_f32_16x16x32_bf16 v[144:147], v[24:27], v[212:215], v[144:147]
    v_mfma_f32_16x16x32_bf16 v[148:151], v[56:59], v[212:215], v[148:151]
    v_mfma_f32_16x16x32_bf16 v[152:155], v[88:91], v[212:215], v[152:155]
    v_mfma_f32_16x16x32_bf16 v[156:159], v[120:123], v[212:215], v[156:159]
    ds_read_b128 v[200:203], v249 offset:64
    v_exp_f32 v166, v166
    v_exp_f32 v167, v167
    s_waitcnt lgkmcnt(4)
    v_mfma_f32_16x16x32_bf16 v[128:131], v[28:31], v[216:219], v[128:131]
    v_mfma_f32_16x16x32_bf16 v[132:135], v[60:63], v[216:219], v[132:135]
    v_mfma_f32_16x16x32_bf16 v[136:139], v[92:95], v[216:219], v[136:139]
    v_mfma_f32_16x16x32_bf16 v[140:143], v[124:127], v[216:219], v[140:143]
    ds_read_b128 v[204:207], v249 offset:8512
    s_waitcnt lgkmcnt(4)
    v_mfma_f32_16x16x32_bf16 v[144:147], v[28:31], v[220:223], v[144:147]
    v_mfma_f32_16x16x32_bf16 v[148:151], v[60:63], v[220:223], v[148:151]
    v_mfma_f32_16x16x32_bf16 v[152:155], v[92:95], v[220:223], v[152:155]
    v_mfma_f32_16x16x32_bf16 v[156:159], v[124:127], v[220:223], v[156:159]
    ds_read_b128 v[208:211], v249 offset:128
    v_fma_f32 v168, v168, s35, -v240
    v_fma_f32 v169, v169, s35, -v240
    v_add_f32 v242, v242, v166
    v_add_f32 v242, v242, v167
    v_cvt_pk_bf16_f32 v227, v166, v167
    ds_write_b128 v251, v[224:227] offset:16384
    v_exp_f32 v168, v168
    v_exp_f32 v169, v169
    v_fma_f32 v170, v170, s35, -v240
    v_fma_f32 v171, v171, s35, -v240
    v_add_f32 v242, v242, v168
    v_add_f32 v242, v242, v169
    v_cvt_pk_bf16_f32 v228, v168, v169
    v_exp_f32 v170, v170
    v_exp_f32 v171, v171
    v_fma_f32 v172, v172, s35, -v240
    v_fma_f32 v173, v173, s35, -v240
    v_max3_f32 v244, v128, v129, v130
    v_add_f32 v242, v242, v170
    v_add_f32 v242, v242, v171
    v_cvt_pk_bf16_f32 v229, v170, v171
    v_max3_f32 v245, v144, v145, v146
    v_exp_f32 v172, v172
    v_exp_f32 v173, v173
    v_fma_f32 v174, v174, s35, -v240
    v_max3_f32 v244, v244, v131, v132
    v_fma_f32 v175, v175, s35, -v240
    v_add_f32 v242, v242, v172
    v_add_f32 v242, v242, v173
    v_max3_f32 v245, v245, v147, v148
    v_cvt_pk_bf16_f32 v230, v172, v173
    v_exp_f32 v174, v174
    v_exp_f32 v175, v175
    v_max3_f32 v244, v244, v133, v134
    v_fma_f32 v176, v176, s35, -v241
    v_fma_f32 v177, v177, s35, -v241
    v_add_f32 v242, v242, v174
    v_max3_f32 v245, v245, v149, v150
    v_add_f32 v242, v242, v175
    v_cvt_pk_bf16_f32 v231, v174, v175
    ds_write_b128 v251, v[228:231] offset:18432
    v_max3_f32 v244, v244, v135, v136
    v_exp_f32 v176, v176
    v_exp_f32 v177, v177
    v_fma_f32 v178, v178, s35, -v241
    v_max3_f32 v245, v245, v151, v152
    v_fma_f32 v179, v179, s35, -v241
    v_add_f32 v243, v176, v177
    v_cvt_pk_bf16_f32 v224, v176, v177
    v_max3_f32 v244, v244, v137, v138
    v_exp_f32 v178, v178
    v_exp_f32 v179, v179
    v_fma_f32 v180, v180, s35, -v241
    v_max3_f32 v245, v245, v153, v154
    v_fma_f32 v181, v181, s35, -v241
    v_add_f32 v243, v243, v178
    v_add_f32 v243, v243, v179
    v_max3_f32 v244, v244, v139, v140
    v_cvt_pk_bf16_f32 v225, v178, v179
    v_exp_f32 v180, v180
    v_exp_f32 v181, v181
    v_max3_f32 v245, v245, v155, v156
    v_fma_f32 v182, v182, s35, -v241
    v_fma_f32 v183, v183, s35, -v241
    v_add_f32 v243, v243, v180
    v_max3_f32 v244, v244, v141, v142
    v_add_f32 v243, v243, v181
    v_cvt_pk_bf16_f32 v226, v180, v181
    v_exp_f32 v182, v182
    v_max3_f32 v245, v245, v157, v158
    v_exp_f32 v183, v183
    v_fma_f32 v184, v184, s35, -v241
    v_fma_f32 v185, v185, s35, -v241
    v_max_f32 v244, v244, v143
    v_add_f32 v243, v243, v182
    v_add_f32 v243, v243, v183
    v_cvt_pk_bf16_f32 v227, v182, v183
    v_max_f32 v245, v245, v159
    ds_write_b128 v251, v[224:227] offset:17408
    v_exp_f32 v184, v184
    v_exp_f32 v185, v185
    v_fma_f32 v186, v186, s35, -v241
    v_fma_f32 v187, v187, s35, -v241
    v_add_f32 v243, v243, v184
    v_add_f32 v243, v243, v185
    v_cvt_pk_bf16_f32 v228, v184, v185
    v_exp_f32 v186, v186
    v_exp_f32 v187, v187
    v_fma_f32 v188, v188, s35, -v241
    v_fma_f32 v189, v189, s35, -v241
    v_add_f32 v243, v243, v186
    v_add_f32 v243, v243, v187
    v_cvt_pk_bf16_f32 v229, v186, v187
    v_exp_f32 v188, v188
    v_exp_f32 v189, v189
    v_fma_f32 v190, v190, s35, -v241
    v_fma_f32 v191, v191, s35, -v241
    v_add_f32 v243, v243, v188
    v_add_f32 v243, v243, v189
    v_cvt_pk_bf16_f32 v230, v188, v189
    v_exp_f32 v190, v190
    v_exp_f32 v191, v191
    v_add_f32 v243, v243, v190
    v_add_f32 v243, v243, v191
    v_cvt_pk_bf16_f32 v231, v190, v191
    ds_write_b128 v251, v[228:231] offset:19456
    v_permlane32_swap_b32 v244, v245
    v_permlane32_swap_b32 v242, v243
    v_max_f32 v244, v244, v245
    v_add_f32 v242, v242, v243
    s_nop 1
    v_permlane16_swap_b32 v244, v242
    v_max_f32 v246, v244, v242
    v_add_f32 v247, v244, v242
    v_cndmask_b32 v246, v247, v246, s[40:41]
    ds_write_b32 v252, v246 offset:1024
    s_waitcnt lgkmcnt(0)
    s_barrier
    s_add_u32 s34, s34, 1
    s_branch L_qk_loop
L_qk_tail:
    s_nop 7
    s_nop 7
    s_add_u32 s34, s34, 1
    s_setprio 0
    ds_read_b128 v[232:235], v253
    ds_read_b128 v[224:227], v253 offset:256
    s_waitcnt lgkmcnt(1)
    v_max3_f32 v246, v232, v233, v234
    v_max_f32 v246, v246, v235
    v_mul_f32 v240, s35, v246
    v_mov_b32 v244, 0
    s_waitcnt lgkmcnt(0)
    v_max3_f32 v246, v224, v225, v226
    v_max_f32 v246, v246, v227
    v_mul_f32 v241, s35, v246
    v_mov_b32 v245, 0
    v_fma_f32 v160, v160, s35, -v240
    v_fma_f32 v161, v161, s35, -v240
    v_exp_f32 v160, v160
    v_exp_f32 v161, v161
    v_fma_f32 v162, v162, s35, -v240
    v_fma_f32 v163, v163, s35, -v240
    v_add_f32 v242, v160, v161
    v_cvt_pk_bf16_f32 v224, v160, v161
    v_exp_f32 v162, v162
    v_exp_f32 v163, v163
    v_fma_f32 v164, v164, s35, -v240
    v_fma_f32 v165, v165, s35, -v240
    v_add_f32 v242, v242, v162
    v_add_f32 v242, v242, v163
    v_cvt_pk_bf16_f32 v225, v162, v163
    v_exp_f32 v164, v164
    v_exp_f32 v165, v165
    v_fma_f32 v166, v166, s35, -v240
    v_fma_f32 v167, v167, s35, -v240
    v_add_f32 v242, v242, v164
    v_add_f32 v242, v242, v165
    v_cvt_pk_bf16_f32 v226, v164, v165
    v_exp_f32 v166, v166
    v_exp_f32 v167, v167
    v_fma_f32 v168, v168, s35, -v240
    v_fma_f32 v169, v169, s35, -v240
    v_add_f32 v242, v242, v166
    v_add_f32 v242, v242, v167
    v_cvt_pk_bf16_f32 v227, v166, v167
    ds_write_b128 v251, v[224:227] offset:16384
    v_exp_f32 v168, v168
    v_exp_f32 v169, v169
    v_fma_f32 v170, v170, s35, -v240
    v_fma_f32 v171, v171, s35, -v240
    v_add_f32 v242, v242, v168
    v_add_f32 v242, v242, v169
    v_cvt_pk_bf16_f32 v228, v168, v169
    v_exp_f32 v170, v170
    v_exp_f32 v171, v171
    v_fma_f32 v172, v172, s35, -v240
    v_fma_f32 v173, v173, s35, -v240
    v_add_f32 v242, v242, v170
    v_add_f32 v242, v242, v171
    v_cvt_pk_bf16_f32 v229, v170, v171
    v_exp_f32 v172, v172
    v_exp_f32 v173, v173
    v_fma_f32 v174, v174, s35, -v240
    v_fma_f32 v175, v175, s35, -v240
    v_add_f32 v242, v242, v172
    v_add_f32 v242, v242, v173
    v_cvt_pk_bf16_f32 v230, v172, v173
    v_exp_f32 v174, v174
    v_exp_f32 v175, v175
    v_fma_f32 v176, v176, s35, -v241
    v_fma_f32 v177, v177, s35, -v241
    v_add_f32 v242, v242, v174
    v_add_f32 v242, v242, v175
    v_cvt_pk_bf16_f32 v231, v174, v175
    ds_write_b128 v251, v[228:231] offset:18432
    v_exp_f32 v176, v176
    v_exp_f32 v177, v177
    v_fma_f32 v178, v178, s35, -v241
    v_fma_f32 v179, v179, s35, -v241
    v_add_f32 v243, v176, v177
    v_cvt_pk_bf16_f32 v224, v176, v177
    v_exp_f32 v178, v178
    v_exp_f32 v179, v179
    v_fma_f32 v180, v180, s35, -v241
    v_fma_f32 v181, v181, s35, -v241
    v_add_f32 v243, v243, v178
    v_add_f32 v243, v243, v179
    v_cvt_pk_bf16_f32 v225, v178, v179
    v_exp_f32 v180, v180
    v_exp_f32 v181, v181
    v_fma_f32 v182, v182, s35, -v241
    v_fma_f32 v183, v183, s35, -v241
    v_add_f32 v243, v243, v180
    v_add_f32 v243, v243, v181
    v_cvt_pk_bf16_f32 v226, v180, v181
    v_exp_f32 v182, v182
    v_exp_f32 v183, v183
    v_fma_f32 v184, v184, s35, -v241
    v_fma_f32 v185, v185, s35, -v241
    v_add_f32 v243, v243, v182
    v_add_f32 v243, v243, v183
    v_cvt_pk_bf16_f32 v227, v182, v183
    ds_write_b128 v251, v[224:227] offset:17408
    v_exp_f32 v184, v184
    v_exp_f32 v185, v185
    v_fma_f32 v186, v186, s35, -v241
    v_fma_f32 v187, v187, s35, -v241
    v_add_f32 v243, v243, v184
    v_add_f32 v243, v243, v185
    v_cvt_pk_bf16_f32 v228, v184, v185
    v_exp_f32 v186, v186
    v_exp_f32 v187, v187
    v_fma_f32 v188, v188, s35, -v241
    v_fma_f32 v189, v189, s35, -v241
    v_add_f32 v243, v243, v186
    v_add_f32 v243, v243, v187
    v_cvt_pk_bf16_f32 v229, v186, v187
    v_exp_f32 v188, v188
    v_exp_f32 v189, v189
    v_fma_f32 v190, v190, s35, -v241
    v_fma_f32 v191, v191, s35, -v241
    v_add_f32 v243, v243, v188
    v_add_f32 v243, v243, v189
    v_cvt_pk_bf16_f32 v230, v188, v189
    v_exp_f32 v190, v190
    v_exp_f32 v191, v191
    v_add_f32 v243, v243, v190
    v_add_f32 v243, v243, v191
    v_cvt_pk_bf16_f32 v231, v190, v191
    ds_write_b128 v251, v[228:231] offset:19456
    v_permlane32_swap_b32 v244, v245
    v_permlane32_swap_b32 v242, v243
    v_max_f32 v244, v244, v245
    v_add_f32 v242, v242, v243
    s_nop 1
    v_permlane16_swap_b32 v244, v242
    v_max_f32 v246, v244, v242
    v_add_f32 v247, v244, v242
    v_cndmask_b32 v246, v247, v246, s[40:41]
    ds_write_b32 v252, v246 offset:1024
    s_waitcnt lgkmcnt(0)
    s_barrier
    s_endpgm
L_pv:
    s_and_b32 s53, s2, 31
    s_lshl_b32 s53, s53, 3
    s_add_u32 s53, s53, s28
    s_cmp_lg_u32 s53, 44
    s_cbranch_scc1 L_nocpf
    s_getpc_b64 s[56:57]
L_pc_pv:
    s_sub_u32 s56, s56, L_pc_pv-standalone__gqa_softmax__near_ridge_kernel
    s_subb_u32 s57, s57, 0
    v_lshlrev_b32 v125, 6, v255
    v_add_u32 v126, 1024, v125
    global_load_dword v127, v126, s[56:57]
    v_add_u32 v126, 5120, v125
    global_load_dword v127, v126, s[56:57]
    v_add_u32 v126, 9216, v125
    global_load_dword v127, v126, s[56:57]
    v_add_u32 v126, 13312, v125
    global_load_dword v127, v126, s[56:57]
    v_add_u32 v126, 17408, v125
    global_load_dword v127, v126, s[56:57]
    v_add_u32 v126, 21504, v125
    global_load_dword v127, v126, s[56:57]
    v_add_u32 v126, 25600, v125
    v_min_u32 v126, 25800, v126
    global_load_dword v127, v126, s[56:57]
L_nocpf:
    s_add_u32 s4, s24, s37
    s_addc_u32 s5, s25, 0
    s_and_b32 s5, s5, 0xffff
    s_mov_b32 s6, 131072
    s_mov_b32 s7, 0x00020000
    s_add_u32 s12, s26, s36
    s_addc_u32 s13, s27, 0
    s_and_b32 s13, s13, 0xffff
    s_mov_b32 s14, 0
    s_mov_b32 s15, 0x00020000
    s_lshl_b32 s38, s29, 7
    v_lshrrev_b32 v130, 3, v255
    v_and_b32 v131, 7, v255
    v_lshlrev_b32 v132, 9, v130
    v_lshl_add_u32 v132, v131, 4, v132
    v_add_u32 v253, s38, v132
    v_bfe_u32 v132, v255, 4, 1
    v_lshlrev_b32 v132, 4, v132
    v_xor_b32 v252, v132, v253
    s_lshl_b32 s36, s29, 12
    s_add_u32 s36, s36, 134144
    v_lshlrev_b32 v130, 4, v255
    v_add_u32 v250, 101376, v130
    v_add_u32 v242, 16896, v130
    v_and_b32 v130, 15, v255
    v_lshlrev_b32 v130, 4, v130
    v_add_u32 v251, 151040, v130
    v_lshrrev_b32 v130, 2, v255
    v_lshlrev_b32 v130, 7, v130
    v_and_b32 v131, 3, v255
    v_lshl_add_u32 v130, v131, 5, v130
    v_bfe_u32 v131, v255, 3, 1
    v_lshl_add_u32 v248, v131, 4, v130
    v_xor_b32 v254, 16, v248
    s_mov_b32 s30, 163840
    s_add_u32 s31, s44, 67584
    s_add_u32 s45, s44, 101376
    s_mov_b32 s33, 0
    s_mov_b32 s34, 5
    s_setprio 0
    s_barrier
    s_add_u32 m0, s44, 50688
    s_mov_b32 s38, 0
    buffer_load_dwordx4 v252, s[4:7], s38 offen nt lds
    s_add_u32 m0, s44, 51712
    s_mov_b32 s38, 4096
    buffer_load_dwordx4 v252, s[4:7], s38 offen nt lds
    s_add_u32 m0, s44, 52736
    s_mov_b32 s38, 8192
    buffer_load_dwordx4 v252, s[4:7], s38 offen nt lds
    s_add_u32 m0, s44, 53760
    s_mov_b32 s38, 12288
    buffer_load_dwordx4 v252, s[4:7], s38 offen nt lds
    s_add_u32 m0, s44, 67584
    s_mov_b32 s38, 16384
    buffer_load_dwordx4 v252, s[4:7], s38 offen nt lds
    s_add_u32 m0, s44, 68608
    s_mov_b32 s38, 20480
    buffer_load_dwordx4 v252, s[4:7], s38 offen nt lds
    s_add_u32 m0, s44, 69632
    s_mov_b32 s38, 24576
    buffer_load_dwordx4 v252, s[4:7], s38 offen nt lds
    s_add_u32 m0, s44, 70656
    s_mov_b32 s38, 28672
    buffer_load_dwordx4 v252, s[4:7], s38 offen nt lds
    s_barrier
    s_add_u32 m0, s44, 84480
    s_mov_b32 s38, 32768
    buffer_load_dwordx4 v252, s[4:7], s38 offen nt lds
    s_add_u32 m0, s44, 85504
    s_mov_b32 s38, 36864
    buffer_load_dwordx4 v252, s[4:7], s38 offen nt lds
    s_add_u32 m0, s44, 86528
    s_mov_b32 s38, 40960
    buffer_load_dwordx4 v252, s[4:7], s38 offen nt lds
    s_add_u32 m0, s44, 87552
    s_mov_b32 s38, 45056
    buffer_load_dwordx4 v252, s[4:7], s38 offen nt lds
    s_add_u32 m0, s36, 0
    s_mov_b32 s38, 49152
    buffer_load_dwordx4 v252, s[4:7], s38 offen nt lds
    s_add_u32 m0, s36, 1024
    s_mov_b32 s38, 53248
    buffer_load_dwordx4 v252, s[4:7], s38 offen nt lds
    s_add_u32 m0, s36, 2048
    s_mov_b32 s38, 57344
    buffer_load_dwordx4 v252, s[4:7], s38 offen nt lds
    s_add_u32 m0, s36, 3072
    s_mov_b32 s38, 61440
    buffer_load_dwordx4 v252, s[4:7], s38 offen nt lds
    s_barrier
    s_add_u32 m0, s44, 0
    s_mov_b32 s38, 65536
    buffer_load_dwordx4 v252, s[4:7], s38 offen nt lds
    s_add_u32 m0, s44, 1024
    s_mov_b32 s38, 69632
    buffer_load_dwordx4 v252, s[4:7], s38 offen nt lds
    s_add_u32 m0, s44, 2048
    s_mov_b32 s38, 73728
    buffer_load_dwordx4 v252, s[4:7], s38 offen nt lds
    s_add_u32 m0, s44, 3072
    s_mov_b32 s38, 77824
    buffer_load_dwordx4 v252, s[4:7], s38 offen nt lds
    s_waitcnt vmcnt(16)
    s_add_u32 s53, s44, 50688
    v_add_u32 v240, s53, v248
    v_add_u32 v241, s53, v254
    ds_read_b64_tr_b16 v[0:1], v240
    ds_read_b64_tr_b16 v[2:3], v240 offset:2048
    ds_read_b64_tr_b16 v[32:33], v240 offset:8
    ds_read_b64_tr_b16 v[34:35], v240 offset:2056
    ds_read_b64_tr_b16 v[64:65], v241
    ds_read_b64_tr_b16 v[66:67], v241 offset:2048
    ds_read_b64_tr_b16 v[96:97], v241 offset:8
    ds_read_b64_tr_b16 v[98:99], v241 offset:2056
    s_waitcnt lgkmcnt(0)
    s_add_u32 m0, s44, 50688
    s_mov_b32 s38, 49152
    buffer_load_dwordx4 v249, s[8:11], s38 offen nt lds
    s_add_u32 m0, s44, 51744
    s_mov_b32 s38, 50176
    buffer_load_dwordx4 v249, s[8:11], s38 offen nt lds
    s_add_u32 m0, s44, 52800
    s_mov_b32 s38, 51200
    buffer_load_dwordx4 v249, s[8:11], s38 offen nt lds
    s_add_u32 m0, s44, 53856
    s_mov_b32 s38, 52224
    buffer_load_dwordx4 v249, s[8:11], s38 offen nt lds
    s_barrier
    ds_read_b128 v[192:195], v251
    ds_read_b128 v[196:199], v251 offset:256
    s_waitcnt lgkmcnt(1)
    v_add_f32 v192, v192, v193
    v_add_f32 v194, v194, v195
    v_add_f32 v192, v192, v194
    v_rcp_f32 v244, v192
    s_waitcnt lgkmcnt(0)
    v_add_f32 v196, v196, v197
    v_add_f32 v198, v198, v199
    v_add_f32 v196, v196, v198
    v_rcp_f32 v245, v196
    s_waitcnt vmcnt(16)
    s_add_u32 s53, s44, 67584
    v_add_u32 v240, s53, v248
    v_add_u32 v241, s53, v254
    ds_read_b64_tr_b16 v[4:5], v240
    ds_read_b64_tr_b16 v[6:7], v240 offset:2048
    ds_read_b64_tr_b16 v[36:37], v240 offset:8
    ds_read_b64_tr_b16 v[38:39], v240 offset:2056
    ds_read_b64_tr_b16 v[68:69], v241
    ds_read_b64_tr_b16 v[70:71], v241 offset:2048
    ds_read_b64_tr_b16 v[100:101], v241 offset:8
    ds_read_b64_tr_b16 v[102:103], v241 offset:2056
    s_waitcnt lgkmcnt(0)
    s_add_u32 m0, s44, 67584
    s_mov_b32 s38, 65536
    buffer_load_dwordx4 v249, s[8:11], s38 offen nt lds
    s_add_u32 m0, s44, 68640
    s_mov_b32 s38, 66560
    buffer_load_dwordx4 v249, s[8:11], s38 offen nt lds
    s_add_u32 m0, s44, 69696
    s_mov_b32 s38, 67584
    buffer_load_dwordx4 v249, s[8:11], s38 offen nt lds
    s_add_u32 m0, s44, 70752
    s_mov_b32 s38, 68608
    buffer_load_dwordx4 v249, s[8:11], s38 offen nt lds
    s_barrier
    s_add_u32 m0, s44, 33792
    s_mov_b32 s38, 81920
    buffer_load_dwordx4 v252, s[4:7], s38 offen nt lds
    s_add_u32 m0, s44, 34816
    s_mov_b32 s38, 86016
    buffer_load_dwordx4 v252, s[4:7], s38 offen nt lds
    s_add_u32 m0, s44, 35840
    s_mov_b32 s38, 90112
    buffer_load_dwordx4 v252, s[4:7], s38 offen nt lds
    s_add_u32 m0, s44, 36864
    s_mov_b32 s38, 94208
    buffer_load_dwordx4 v252, s[4:7], s38 offen nt lds
    ds_read_b128 v[192:195], v251 offset:1024
    ds_read_b128 v[196:199], v251 offset:1280
    s_waitcnt lgkmcnt(1)
    v_add_f32 v192, v192, v193
    v_add_f32 v194, v194, v195
    v_add_f32 v192, v192, v194
    v_rcp_f32 v246, v192
    s_waitcnt lgkmcnt(0)
    v_add_f32 v196, v196, v197
    v_add_f32 v198, v198, v199
    v_add_f32 v196, v196, v198
    v_rcp_f32 v247, v196
    s_waitcnt vmcnt(20)
    s_add_u32 s53, s44, 84480
    v_add_u32 v240, s53, v248
    v_add_u32 v241, s53, v254
    ds_read_b64_tr_b16 v[8:9], v240
    ds_read_b64_tr_b16 v[10:11], v240 offset:2048
    ds_read_b64_tr_b16 v[40:41], v240 offset:8
    ds_read_b64_tr_b16 v[42:43], v240 offset:2056
    ds_read_b64_tr_b16 v[72:73], v241
    ds_read_b64_tr_b16 v[74:75], v241 offset:2048
    ds_read_b64_tr_b16 v[104:105], v241 offset:8
    ds_read_b64_tr_b16 v[106:107], v241 offset:2056
    s_waitcnt lgkmcnt(0)
    s_barrier
    s_waitcnt vmcnt(16)
    s_add_u32 s53, s36, 0
    v_add_u32 v240, s53, v248
    v_add_u32 v241, s53, v254
    ds_read_b64_tr_b16 v[12:13], v240
    ds_read_b64_tr_b16 v[14:15], v240 offset:2048
    ds_read_b64_tr_b16 v[44:45], v240 offset:8
    ds_read_b64_tr_b16 v[46:47], v240 offset:2056
    ds_read_b64_tr_b16 v[76:77], v241
    ds_read_b64_tr_b16 v[78:79], v241 offset:2048
    ds_read_b64_tr_b16 v[108:109], v241 offset:8
    ds_read_b64_tr_b16 v[110:111], v241 offset:2056
    s_waitcnt lgkmcnt(0)
    s_add_u32 m0, s36, 0
    s_mov_b32 s38, 98304
    buffer_load_dwordx4 v252, s[4:7], s38 offen nt lds
    s_add_u32 m0, s36, 1024
    s_mov_b32 s38, 102400
    buffer_load_dwordx4 v252, s[4:7], s38 offen nt lds
    s_add_u32 m0, s36, 2048
    s_mov_b32 s38, 106496
    buffer_load_dwordx4 v252, s[4:7], s38 offen nt lds
    s_add_u32 m0, s36, 3072
    s_mov_b32 s38, 110592
    buffer_load_dwordx4 v252, s[4:7], s38 offen nt lds
    ds_read_b128 v[192:195], v250
    ds_read_b128 v[196:199], v250 offset:1024
    ds_read_b128 v[200:203], v250 offset:16384
    ds_read_b128 v[204:207], v250 offset:17408
    s_waitcnt lgkmcnt(3)
    v_mfma_f32_16x16x32_bf16 v[208:211], v[0:3], v[192:195], 0
    v_mfma_f32_16x16x32_bf16 v[212:215], v[32:35], v[192:195], 0
    v_mfma_f32_16x16x32_bf16 v[216:219], v[64:67], v[192:195], 0
    v_mfma_f32_16x16x32_bf16 v[220:223], v[96:99], v[192:195], 0
    ds_read_b128 v[192:195], v242
    s_waitcnt lgkmcnt(3)
    v_mfma_f32_16x16x32_bf16 v[224:227], v[0:3], v[196:199], 0
    v_mfma_f32_16x16x32_bf16 v[228:231], v[32:35], v[196:199], 0
    v_mfma_f32_16x16x32_bf16 v[232:235], v[64:67], v[196:199], 0
    v_mfma_f32_16x16x32_bf16 v[236:239], v[96:99], v[196:199], 0
    ds_read_b128 v[196:199], v242 offset:1024
    s_waitcnt lgkmcnt(3)
    v_mfma_f32_16x16x32_bf16 v[160:163], v[0:3], v[200:203], 0
    v_mfma_f32_16x16x32_bf16 v[164:167], v[32:35], v[200:203], 0
    v_mfma_f32_16x16x32_bf16 v[168:171], v[64:67], v[200:203], 0
    v_mfma_f32_16x16x32_bf16 v[172:175], v[96:99], v[200:203], 0
    s_waitcnt lgkmcnt(2)
    v_mfma_f32_16x16x32_bf16 v[176:179], v[0:3], v[204:207], 0
    v_mfma_f32_16x16x32_bf16 v[180:183], v[32:35], v[204:207], 0
    v_mfma_f32_16x16x32_bf16 v[184:187], v[64:67], v[204:207], 0
    v_mfma_f32_16x16x32_bf16 v[188:191], v[96:99], v[204:207], 0
    s_waitcnt lgkmcnt(1)
    v_mfma_f32_16x16x32_bf16 v[128:131], v[0:3], v[192:195], 0
    v_mfma_f32_16x16x32_bf16 v[132:135], v[32:35], v[192:195], 0
    v_mfma_f32_16x16x32_bf16 v[136:139], v[64:67], v[192:195], 0
    v_mfma_f32_16x16x32_bf16 v[140:143], v[96:99], v[192:195], 0
    s_waitcnt lgkmcnt(0)
    v_mfma_f32_16x16x32_bf16 v[144:147], v[0:3], v[196:199], 0
    v_mfma_f32_16x16x32_bf16 v[148:151], v[32:35], v[196:199], 0
    v_mfma_f32_16x16x32_bf16 v[152:155], v[64:67], v[196:199], 0
    v_mfma_f32_16x16x32_bf16 v[156:159], v[96:99], v[196:199], 0
    ds_read_b128 v[192:195], v250 offset:2048
    ds_read_b128 v[196:199], v250 offset:3072
    ds_read_b128 v[200:203], v250 offset:18432
    ds_read_b128 v[204:207], v250 offset:19456
    s_waitcnt lgkmcnt(3)
    v_mfma_f32_16x16x32_bf16 v[208:211], v[4:7], v[192:195], v[208:211]
    v_mfma_f32_16x16x32_bf16 v[212:215], v[36:39], v[192:195], v[212:215]
    v_mfma_f32_16x16x32_bf16 v[216:219], v[68:71], v[192:195], v[216:219]
    v_mfma_f32_16x16x32_bf16 v[220:223], v[100:103], v[192:195], v[220:223]
    ds_read_b128 v[192:195], v242 offset:2048
    s_waitcnt lgkmcnt(3)
    v_mfma_f32_16x16x32_bf16 v[224:227], v[4:7], v[196:199], v[224:227]
    v_mfma_f32_16x16x32_bf16 v[228:231], v[36:39], v[196:199], v[228:231]
    v_mfma_f32_16x16x32_bf16 v[232:235], v[68:71], v[196:199], v[232:235]
    v_mfma_f32_16x16x32_bf16 v[236:239], v[100:103], v[196:199], v[236:239]
    ds_read_b128 v[196:199], v242 offset:3072
    s_waitcnt lgkmcnt(3)
    v_mfma_f32_16x16x32_bf16 v[160:163], v[4:7], v[200:203], v[160:163]
    v_mfma_f32_16x16x32_bf16 v[164:167], v[36:39], v[200:203], v[164:167]
    v_mfma_f32_16x16x32_bf16 v[168:171], v[68:71], v[200:203], v[168:171]
    v_mfma_f32_16x16x32_bf16 v[172:175], v[100:103], v[200:203], v[172:175]
    s_waitcnt lgkmcnt(2)
    v_mfma_f32_16x16x32_bf16 v[176:179], v[4:7], v[204:207], v[176:179]
    v_mfma_f32_16x16x32_bf16 v[180:183], v[36:39], v[204:207], v[180:183]
    v_mfma_f32_16x16x32_bf16 v[184:187], v[68:71], v[204:207], v[184:187]
    v_mfma_f32_16x16x32_bf16 v[188:191], v[100:103], v[204:207], v[188:191]
    s_waitcnt lgkmcnt(1)
    v_mfma_f32_16x16x32_bf16 v[128:131], v[4:7], v[192:195], v[128:131]
    v_mfma_f32_16x16x32_bf16 v[132:135], v[36:39], v[192:195], v[132:135]
    v_mfma_f32_16x16x32_bf16 v[136:139], v[68:71], v[192:195], v[136:139]
    v_mfma_f32_16x16x32_bf16 v[140:143], v[100:103], v[192:195], v[140:143]
    s_waitcnt lgkmcnt(0)
    v_mfma_f32_16x16x32_bf16 v[144:147], v[4:7], v[196:199], v[144:147]
    v_mfma_f32_16x16x32_bf16 v[148:151], v[36:39], v[196:199], v[148:151]
    v_mfma_f32_16x16x32_bf16 v[152:155], v[68:71], v[196:199], v[152:155]
    v_mfma_f32_16x16x32_bf16 v[156:159], v[100:103], v[196:199], v[156:159]
    s_waitcnt vmcnt(16)
    s_add_u32 s53, s44, 0
    v_add_u32 v240, s53, v248
    v_add_u32 v241, s53, v254
    ds_read_b64_tr_b16 v[16:17], v240
    ds_read_b64_tr_b16 v[18:19], v240 offset:2048
    ds_read_b64_tr_b16 v[48:49], v240 offset:8
    ds_read_b64_tr_b16 v[50:51], v240 offset:2056
    ds_read_b64_tr_b16 v[80:81], v241
    ds_read_b64_tr_b16 v[82:83], v241 offset:2048
    ds_read_b64_tr_b16 v[112:113], v241 offset:8
    ds_read_b64_tr_b16 v[114:115], v241 offset:2056
    s_waitcnt lgkmcnt(0)
    s_add_u32 m0, s44, 0
    s_mov_b32 s38, 114688
    buffer_load_dwordx4 v252, s[4:7], s38 offen nt lds
    s_add_u32 m0, s44, 1024
    s_mov_b32 s38, 118784
    buffer_load_dwordx4 v252, s[4:7], s38 offen nt lds
    s_add_u32 m0, s44, 2048
    s_mov_b32 s38, 122880
    buffer_load_dwordx4 v252, s[4:7], s38 offen nt lds
    s_add_u32 m0, s44, 3072
    s_mov_b32 s38, 126976
    buffer_load_dwordx4 v252, s[4:7], s38 offen nt lds
    s_add_u32 m0, s44, 84480
    s_mov_b32 s38, 81920
    buffer_load_dwordx4 v249, s[8:11], s38 offen nt lds
    s_add_u32 m0, s44, 85536
    s_mov_b32 s38, 82944
    buffer_load_dwordx4 v249, s[8:11], s38 offen nt lds
    s_add_u32 m0, s44, 86592
    s_mov_b32 s38, 83968
    buffer_load_dwordx4 v249, s[8:11], s38 offen nt lds
    s_add_u32 m0, s44, 87648
    s_mov_b32 s38, 84992
    buffer_load_dwordx4 v249, s[8:11], s38 offen nt lds
    ds_read_b128 v[192:195], v250 offset:4096
    ds_read_b128 v[196:199], v250 offset:5120
    ds_read_b128 v[200:203], v250 offset:20480
    ds_read_b128 v[204:207], v250 offset:21504
    s_waitcnt lgkmcnt(3)
    v_mfma_f32_16x16x32_bf16 v[208:211], v[8:11], v[192:195], v[208:211]
    v_mfma_f32_16x16x32_bf16 v[212:215], v[40:43], v[192:195], v[212:215]
    v_mfma_f32_16x16x32_bf16 v[216:219], v[72:75], v[192:195], v[216:219]
    v_mfma_f32_16x16x32_bf16 v[220:223], v[104:107], v[192:195], v[220:223]
    ds_read_b128 v[192:195], v242 offset:4096
    s_waitcnt lgkmcnt(3)
    v_mfma_f32_16x16x32_bf16 v[224:227], v[8:11], v[196:199], v[224:227]
    v_mfma_f32_16x16x32_bf16 v[228:231], v[40:43], v[196:199], v[228:231]
    v_mfma_f32_16x16x32_bf16 v[232:235], v[72:75], v[196:199], v[232:235]
    v_mfma_f32_16x16x32_bf16 v[236:239], v[104:107], v[196:199], v[236:239]
    ds_read_b128 v[196:199], v242 offset:5120
    s_waitcnt lgkmcnt(3)
    v_mfma_f32_16x16x32_bf16 v[160:163], v[8:11], v[200:203], v[160:163]
    v_mfma_f32_16x16x32_bf16 v[164:167], v[40:43], v[200:203], v[164:167]
    v_mfma_f32_16x16x32_bf16 v[168:171], v[72:75], v[200:203], v[168:171]
    v_mfma_f32_16x16x32_bf16 v[172:175], v[104:107], v[200:203], v[172:175]
    s_waitcnt lgkmcnt(2)
    v_mfma_f32_16x16x32_bf16 v[176:179], v[8:11], v[204:207], v[176:179]
    v_mfma_f32_16x16x32_bf16 v[180:183], v[40:43], v[204:207], v[180:183]
    v_mfma_f32_16x16x32_bf16 v[184:187], v[72:75], v[204:207], v[184:187]
    v_mfma_f32_16x16x32_bf16 v[188:191], v[104:107], v[204:207], v[188:191]
    s_waitcnt lgkmcnt(1)
    v_mfma_f32_16x16x32_bf16 v[128:131], v[8:11], v[192:195], v[128:131]
    v_mfma_f32_16x16x32_bf16 v[132:135], v[40:43], v[192:195], v[132:135]
    v_mfma_f32_16x16x32_bf16 v[136:139], v[72:75], v[192:195], v[136:139]
    v_mfma_f32_16x16x32_bf16 v[140:143], v[104:107], v[192:195], v[140:143]
    s_waitcnt lgkmcnt(0)
    v_mfma_f32_16x16x32_bf16 v[144:147], v[8:11], v[196:199], v[144:147]
    v_mfma_f32_16x16x32_bf16 v[148:151], v[40:43], v[196:199], v[148:151]
    v_mfma_f32_16x16x32_bf16 v[152:155], v[72:75], v[196:199], v[152:155]
    v_mfma_f32_16x16x32_bf16 v[156:159], v[104:107], v[196:199], v[156:159]
    s_waitcnt vmcnt(20)
    s_barrier
    ds_read_b128 v[192:195], v250 offset:6144
    ds_read_b128 v[196:199], v250 offset:7168
    ds_read_b128 v[200:203], v250 offset:22528
    ds_read_b128 v[204:207], v250 offset:23552
    s_waitcnt lgkmcnt(3)
    v_mfma_f32_16x16x32_bf16 v[208:211], v[12:15], v[192:195], v[208:211]
    v_mfma_f32_16x16x32_bf16 v[212:215], v[44:47], v[192:195], v[212:215]
    v_mfma_f32_16x16x32_bf16 v[216:219], v[76:79], v[192:195], v[216:219]
    v_mfma_f32_16x16x32_bf16 v[220:223], v[108:111], v[192:195], v[220:223]
    ds_read_b128 v[192:195], v242 offset:6144
    s_waitcnt lgkmcnt(3)
    v_mfma_f32_16x16x32_bf16 v[224:227], v[12:15], v[196:199], v[224:227]
    v_mfma_f32_16x16x32_bf16 v[228:231], v[44:47], v[196:199], v[228:231]
    v_mfma_f32_16x16x32_bf16 v[232:235], v[76:79], v[196:199], v[232:235]
    v_mfma_f32_16x16x32_bf16 v[236:239], v[108:111], v[196:199], v[236:239]
    ds_read_b128 v[196:199], v242 offset:7168
    s_waitcnt lgkmcnt(3)
    v_mfma_f32_16x16x32_bf16 v[160:163], v[12:15], v[200:203], v[160:163]
    v_mfma_f32_16x16x32_bf16 v[164:167], v[44:47], v[200:203], v[164:167]
    v_mfma_f32_16x16x32_bf16 v[168:171], v[76:79], v[200:203], v[168:171]
    v_mfma_f32_16x16x32_bf16 v[172:175], v[108:111], v[200:203], v[172:175]
    s_waitcnt lgkmcnt(2)
    v_mfma_f32_16x16x32_bf16 v[176:179], v[12:15], v[204:207], v[176:179]
    v_mfma_f32_16x16x32_bf16 v[180:183], v[44:47], v[204:207], v[180:183]
    v_mfma_f32_16x16x32_bf16 v[184:187], v[76:79], v[204:207], v[184:187]
    v_mfma_f32_16x16x32_bf16 v[188:191], v[108:111], v[204:207], v[188:191]
    s_waitcnt lgkmcnt(1)
    v_mfma_f32_16x16x32_bf16 v[128:131], v[12:15], v[192:195], v[128:131]
    v_mfma_f32_16x16x32_bf16 v[132:135], v[44:47], v[192:195], v[132:135]
    v_mfma_f32_16x16x32_bf16 v[136:139], v[76:79], v[192:195], v[136:139]
    v_mfma_f32_16x16x32_bf16 v[140:143], v[108:111], v[192:195], v[140:143]
    s_waitcnt lgkmcnt(0)
    v_mfma_f32_16x16x32_bf16 v[144:147], v[12:15], v[196:199], v[144:147]
    v_mfma_f32_16x16x32_bf16 v[148:151], v[44:47], v[196:199], v[148:151]
    v_mfma_f32_16x16x32_bf16 v[152:155], v[76:79], v[196:199], v[152:155]
    v_mfma_f32_16x16x32_bf16 v[156:159], v[108:111], v[196:199], v[156:159]
    ds_read_b128 v[192:195], v250 offset:8192
    ds_read_b128 v[196:199], v250 offset:9216
    ds_read_b128 v[200:203], v250 offset:24576
    ds_read_b128 v[204:207], v250 offset:25600
    s_waitcnt lgkmcnt(3)
    v_mfma_f32_16x16x32_bf16 v[208:211], v[16:19], v[192:195], v[208:211]
    v_mfma_f32_16x16x32_bf16 v[212:215], v[48:51], v[192:195], v[212:215]
    v_mfma_f32_16x16x32_bf16 v[216:219], v[80:83], v[192:195], v[216:219]
    v_mfma_f32_16x16x32_bf16 v[220:223], v[112:115], v[192:195], v[220:223]
    ds_read_b128 v[192:195], v242 offset:8192
    s_waitcnt lgkmcnt(3)
    v_mfma_f32_16x16x32_bf16 v[224:227], v[16:19], v[196:199], v[224:227]
    v_mfma_f32_16x16x32_bf16 v[228:231], v[48:51], v[196:199], v[228:231]
    v_mfma_f32_16x16x32_bf16 v[232:235], v[80:83], v[196:199], v[232:235]
    v_mfma_f32_16x16x32_bf16 v[236:239], v[112:115], v[196:199], v[236:239]
    ds_read_b128 v[196:199], v242 offset:9216
    s_waitcnt lgkmcnt(3)
    v_mfma_f32_16x16x32_bf16 v[160:163], v[16:19], v[200:203], v[160:163]
    v_mfma_f32_16x16x32_bf16 v[164:167], v[48:51], v[200:203], v[164:167]
    v_mfma_f32_16x16x32_bf16 v[168:171], v[80:83], v[200:203], v[168:171]
    v_mfma_f32_16x16x32_bf16 v[172:175], v[112:115], v[200:203], v[172:175]
    s_waitcnt lgkmcnt(2)
    v_mfma_f32_16x16x32_bf16 v[176:179], v[16:19], v[204:207], v[176:179]
    v_mfma_f32_16x16x32_bf16 v[180:183], v[48:51], v[204:207], v[180:183]
    v_mfma_f32_16x16x32_bf16 v[184:187], v[80:83], v[204:207], v[184:187]
    v_mfma_f32_16x16x32_bf16 v[188:191], v[112:115], v[204:207], v[188:191]
    s_waitcnt lgkmcnt(1)
    v_mfma_f32_16x16x32_bf16 v[128:131], v[16:19], v[192:195], v[128:131]
    v_mfma_f32_16x16x32_bf16 v[132:135], v[48:51], v[192:195], v[132:135]
    v_mfma_f32_16x16x32_bf16 v[136:139], v[80:83], v[192:195], v[136:139]
    v_mfma_f32_16x16x32_bf16 v[140:143], v[112:115], v[192:195], v[140:143]
    s_waitcnt lgkmcnt(0)
    v_mfma_f32_16x16x32_bf16 v[144:147], v[16:19], v[196:199], v[144:147]
    v_mfma_f32_16x16x32_bf16 v[148:151], v[48:51], v[196:199], v[148:151]
    v_mfma_f32_16x16x32_bf16 v[152:155], v[80:83], v[196:199], v[152:155]
    v_mfma_f32_16x16x32_bf16 v[156:159], v[112:115], v[196:199], v[156:159]
    s_waitcnt vmcnt(16)
    s_barrier
    s_add_u32 m0, s44, 50688
    s_mov_b32 s38, 147456
    buffer_load_dwordx4 v249, s[8:11], s38 offen nt lds
    s_add_u32 m0, s44, 51744
    s_mov_b32 s38, 148480
    buffer_load_dwordx4 v249, s[8:11], s38 offen nt lds
    s_add_u32 m0, s44, 52800
    s_mov_b32 s38, 149504
    buffer_load_dwordx4 v249, s[8:11], s38 offen nt lds
    s_add_u32 m0, s44, 53856
    s_mov_b32 s38, 150528
    buffer_load_dwordx4 v249, s[8:11], s38 offen nt lds
    s_waitcnt vmcnt(16)
    s_add_u32 s53, s44, 33792
    v_add_u32 v240, s53, v248
    v_add_u32 v241, s53, v254
    ds_read_b64_tr_b16 v[20:21], v240
    ds_read_b64_tr_b16 v[22:23], v240 offset:2048
    ds_read_b64_tr_b16 v[52:53], v240 offset:8
    ds_read_b64_tr_b16 v[54:55], v240 offset:2056
    ds_read_b64_tr_b16 v[84:85], v241
    ds_read_b64_tr_b16 v[86:87], v241 offset:2048
    ds_read_b64_tr_b16 v[116:117], v241 offset:8
    ds_read_b64_tr_b16 v[118:119], v241 offset:2056
    s_waitcnt lgkmcnt(0)
    s_add_u32 m0, s44, 33792
    s_mov_b32 s38, 131072
    buffer_load_dwordx4 v249, s[8:11], s38 offen nt lds
    s_add_u32 m0, s44, 34848
    s_mov_b32 s38, 132096
    buffer_load_dwordx4 v249, s[8:11], s38 offen nt lds
    s_add_u32 m0, s44, 35904
    s_mov_b32 s38, 133120
    buffer_load_dwordx4 v249, s[8:11], s38 offen nt lds
    s_add_u32 m0, s44, 36960
    s_mov_b32 s38, 134144
    buffer_load_dwordx4 v249, s[8:11], s38 offen nt lds
    ds_read_b128 v[192:195], v250 offset:10240
    ds_read_b128 v[196:199], v250 offset:11264
    ds_read_b128 v[200:203], v250 offset:26624
    ds_read_b128 v[204:207], v250 offset:27648
    s_waitcnt lgkmcnt(3)
    v_mfma_f32_16x16x32_bf16 v[208:211], v[20:23], v[192:195], v[208:211]
    v_mfma_f32_16x16x32_bf16 v[212:215], v[52:55], v[192:195], v[212:215]
    v_mfma_f32_16x16x32_bf16 v[216:219], v[84:87], v[192:195], v[216:219]
    v_mfma_f32_16x16x32_bf16 v[220:223], v[116:119], v[192:195], v[220:223]
    ds_read_b128 v[192:195], v242 offset:10240
    s_waitcnt lgkmcnt(3)
    v_mfma_f32_16x16x32_bf16 v[224:227], v[20:23], v[196:199], v[224:227]
    v_mfma_f32_16x16x32_bf16 v[228:231], v[52:55], v[196:199], v[228:231]
    v_mfma_f32_16x16x32_bf16 v[232:235], v[84:87], v[196:199], v[232:235]
    v_mfma_f32_16x16x32_bf16 v[236:239], v[116:119], v[196:199], v[236:239]
    ds_read_b128 v[196:199], v242 offset:11264
    s_waitcnt lgkmcnt(3)
    v_mfma_f32_16x16x32_bf16 v[160:163], v[20:23], v[200:203], v[160:163]
    v_mfma_f32_16x16x32_bf16 v[164:167], v[52:55], v[200:203], v[164:167]
    v_mfma_f32_16x16x32_bf16 v[168:171], v[84:87], v[200:203], v[168:171]
    v_mfma_f32_16x16x32_bf16 v[172:175], v[116:119], v[200:203], v[172:175]
    s_waitcnt lgkmcnt(2)
    v_mfma_f32_16x16x32_bf16 v[176:179], v[20:23], v[204:207], v[176:179]
    v_mfma_f32_16x16x32_bf16 v[180:183], v[52:55], v[204:207], v[180:183]
    v_mfma_f32_16x16x32_bf16 v[184:187], v[84:87], v[204:207], v[184:187]
    v_mfma_f32_16x16x32_bf16 v[188:191], v[116:119], v[204:207], v[188:191]
    s_waitcnt lgkmcnt(1)
    v_mfma_f32_16x16x32_bf16 v[128:131], v[20:23], v[192:195], v[128:131]
    v_mfma_f32_16x16x32_bf16 v[132:135], v[52:55], v[192:195], v[132:135]
    v_mfma_f32_16x16x32_bf16 v[136:139], v[84:87], v[192:195], v[136:139]
    v_mfma_f32_16x16x32_bf16 v[140:143], v[116:119], v[192:195], v[140:143]
    s_waitcnt lgkmcnt(0)
    v_mfma_f32_16x16x32_bf16 v[144:147], v[20:23], v[196:199], v[144:147]
    v_mfma_f32_16x16x32_bf16 v[148:151], v[52:55], v[196:199], v[148:151]
    v_mfma_f32_16x16x32_bf16 v[152:155], v[84:87], v[196:199], v[152:155]
    v_mfma_f32_16x16x32_bf16 v[156:159], v[116:119], v[196:199], v[156:159]
    s_waitcnt vmcnt(16)
    s_add_u32 s53, s36, 0
    v_add_u32 v240, s53, v248
    v_add_u32 v241, s53, v254
    ds_read_b64_tr_b16 v[24:25], v240
    ds_read_b64_tr_b16 v[26:27], v240 offset:2048
    ds_read_b64_tr_b16 v[56:57], v240 offset:8
    ds_read_b64_tr_b16 v[58:59], v240 offset:2056
    ds_read_b64_tr_b16 v[88:89], v241
    ds_read_b64_tr_b16 v[90:91], v241 offset:2048
    ds_read_b64_tr_b16 v[120:121], v241 offset:8
    ds_read_b64_tr_b16 v[122:123], v241 offset:2056
    s_waitcnt lgkmcnt(0)
    ds_read_b128 v[192:195], v250 offset:12288
    ds_read_b128 v[196:199], v250 offset:13312
    ds_read_b128 v[200:203], v250 offset:28672
    ds_read_b128 v[204:207], v250 offset:29696
    s_waitcnt lgkmcnt(3)
    v_mfma_f32_16x16x32_bf16 v[208:211], v[24:27], v[192:195], v[208:211]
    v_mfma_f32_16x16x32_bf16 v[212:215], v[56:59], v[192:195], v[212:215]
    v_mfma_f32_16x16x32_bf16 v[216:219], v[88:91], v[192:195], v[216:219]
    v_mfma_f32_16x16x32_bf16 v[220:223], v[120:123], v[192:195], v[220:223]
    ds_read_b128 v[192:195], v242 offset:12288
    s_waitcnt lgkmcnt(3)
    v_mfma_f32_16x16x32_bf16 v[224:227], v[24:27], v[196:199], v[224:227]
    v_mfma_f32_16x16x32_bf16 v[228:231], v[56:59], v[196:199], v[228:231]
    v_mfma_f32_16x16x32_bf16 v[232:235], v[88:91], v[196:199], v[232:235]
    v_mfma_f32_16x16x32_bf16 v[236:239], v[120:123], v[196:199], v[236:239]
    ds_read_b128 v[196:199], v242 offset:13312
    s_waitcnt lgkmcnt(3)
    v_mfma_f32_16x16x32_bf16 v[160:163], v[24:27], v[200:203], v[160:163]
    v_mfma_f32_16x16x32_bf16 v[164:167], v[56:59], v[200:203], v[164:167]
    v_mfma_f32_16x16x32_bf16 v[168:171], v[88:91], v[200:203], v[168:171]
    v_mfma_f32_16x16x32_bf16 v[172:175], v[120:123], v[200:203], v[172:175]
    s_waitcnt lgkmcnt(2)
    v_mfma_f32_16x16x32_bf16 v[176:179], v[24:27], v[204:207], v[176:179]
    v_mfma_f32_16x16x32_bf16 v[180:183], v[56:59], v[204:207], v[180:183]
    v_mfma_f32_16x16x32_bf16 v[184:187], v[88:91], v[204:207], v[184:187]
    v_mfma_f32_16x16x32_bf16 v[188:191], v[120:123], v[204:207], v[188:191]
    s_waitcnt lgkmcnt(1)
    v_mfma_f32_16x16x32_bf16 v[128:131], v[24:27], v[192:195], v[128:131]
    v_mfma_f32_16x16x32_bf16 v[132:135], v[56:59], v[192:195], v[132:135]
    v_mfma_f32_16x16x32_bf16 v[136:139], v[88:91], v[192:195], v[136:139]
    v_mfma_f32_16x16x32_bf16 v[140:143], v[120:123], v[192:195], v[140:143]
    s_waitcnt lgkmcnt(0)
    v_mfma_f32_16x16x32_bf16 v[144:147], v[24:27], v[196:199], v[144:147]
    v_mfma_f32_16x16x32_bf16 v[148:151], v[56:59], v[196:199], v[148:151]
    v_mfma_f32_16x16x32_bf16 v[152:155], v[88:91], v[196:199], v[152:155]
    v_mfma_f32_16x16x32_bf16 v[156:159], v[120:123], v[196:199], v[156:159]
    s_waitcnt vmcnt(12)
    s_add_u32 s53, s44, 0
    v_add_u32 v240, s53, v248
    v_add_u32 v241, s53, v254
    ds_read_b64_tr_b16 v[28:29], v240
    ds_read_b64_tr_b16 v[30:31], v240 offset:2048
    ds_read_b64_tr_b16 v[60:61], v240 offset:8
    ds_read_b64_tr_b16 v[62:63], v240 offset:2056
    ds_read_b64_tr_b16 v[92:93], v241
    ds_read_b64_tr_b16 v[94:95], v241 offset:2048
    ds_read_b64_tr_b16 v[124:125], v241 offset:8
    ds_read_b64_tr_b16 v[126:127], v241 offset:2056
    s_waitcnt lgkmcnt(0)
    s_add_u32 m0, s44, 0
    s_mov_b32 s38, 98304
    buffer_load_dwordx4 v249, s[8:11], s38 offen nt lds
    s_add_u32 m0, s44, 1056
    s_mov_b32 s38, 99328
    buffer_load_dwordx4 v249, s[8:11], s38 offen nt lds
    s_add_u32 m0, s44, 2112
    s_mov_b32 s38, 100352
    buffer_load_dwordx4 v249, s[8:11], s38 offen nt lds
    s_add_u32 m0, s44, 3168
    s_mov_b32 s38, 101376
    buffer_load_dwordx4 v249, s[8:11], s38 offen nt lds
    ds_read_b128 v[192:195], v250 offset:14336
    ds_read_b128 v[196:199], v250 offset:15360
    ds_read_b128 v[200:203], v250 offset:30720
    ds_read_b128 v[204:207], v250 offset:31744
    s_waitcnt lgkmcnt(3)
    v_mfma_f32_16x16x32_bf16 v[208:211], v[28:31], v[192:195], v[208:211]
    v_mfma_f32_16x16x32_bf16 v[212:215], v[60:63], v[192:195], v[212:215]
    v_mfma_f32_16x16x32_bf16 v[216:219], v[92:95], v[192:195], v[216:219]
    v_mfma_f32_16x16x32_bf16 v[220:223], v[124:127], v[192:195], v[220:223]
    ds_read_b128 v[192:195], v242 offset:14336
    s_waitcnt lgkmcnt(3)
    v_mfma_f32_16x16x32_bf16 v[224:227], v[28:31], v[196:199], v[224:227]
    v_mfma_f32_16x16x32_bf16 v[228:231], v[60:63], v[196:199], v[228:231]
    v_mfma_f32_16x16x32_bf16 v[232:235], v[92:95], v[196:199], v[232:235]
    v_mfma_f32_16x16x32_bf16 v[236:239], v[124:127], v[196:199], v[236:239]
    ds_read_b128 v[196:199], v242 offset:15360
    s_waitcnt lgkmcnt(3)
    v_mfma_f32_16x16x32_bf16 v[160:163], v[28:31], v[200:203], v[160:163]
    v_mfma_f32_16x16x32_bf16 v[164:167], v[60:63], v[200:203], v[164:167]
    v_mfma_f32_16x16x32_bf16 v[168:171], v[92:95], v[200:203], v[168:171]
    v_mfma_f32_16x16x32_bf16 v[172:175], v[124:127], v[200:203], v[172:175]
    s_waitcnt lgkmcnt(2)
    v_mfma_f32_16x16x32_bf16 v[176:179], v[28:31], v[204:207], v[176:179]
    v_mfma_f32_16x16x32_bf16 v[180:183], v[60:63], v[204:207], v[180:183]
    v_mfma_f32_16x16x32_bf16 v[184:187], v[92:95], v[204:207], v[184:187]
    v_mfma_f32_16x16x32_bf16 v[188:191], v[124:127], v[204:207], v[188:191]
    s_waitcnt lgkmcnt(1)
    v_mfma_f32_16x16x32_bf16 v[128:131], v[28:31], v[192:195], v[128:131]
    v_mfma_f32_16x16x32_bf16 v[132:135], v[60:63], v[192:195], v[132:135]
    v_mfma_f32_16x16x32_bf16 v[136:139], v[92:95], v[192:195], v[136:139]
    v_mfma_f32_16x16x32_bf16 v[140:143], v[124:127], v[192:195], v[140:143]
    s_waitcnt lgkmcnt(0)
    v_mfma_f32_16x16x32_bf16 v[144:147], v[28:31], v[196:199], v[144:147]
    v_mfma_f32_16x16x32_bf16 v[148:151], v[60:63], v[196:199], v[148:151]
    v_mfma_f32_16x16x32_bf16 v[152:155], v[92:95], v[196:199], v[152:155]
    v_mfma_f32_16x16x32_bf16 v[156:159], v[124:127], v[196:199], v[156:159]
    s_waitcnt vmcnt(12)
    s_barrier
    v_lshrrev_b32 v192, 3, v255
    v_and_b32 v193, 7, v255
    v_xor_b32 v193, v192, v193
    v_lshlrev_b32 v193, 4, v193
    v_lshl_add_u32 v193, v192, 7, v193
    v_add_u32 v252, s36, v193
    v_and_b32 v192, 15, v255
    v_lshrrev_b32 v193, 4, v255
    v_lshlrev_b32 v193, 1, v193
    v_and_b32 v194, 7, v192
    v_xor_b32 v193, v193, v194
    v_lshlrev_b32 v193, 4, v193
    v_lshl_add_u32 v193, v192, 7, v193
    v_xor_b32 v194, 16, v193
    v_add_u32 v248, s36, v193
    v_add_u32 v254, s36, v194
    s_add_u32 m0, s44, 16896
    s_mov_b32 s38, 114688
    buffer_load_dwordx4 v249, s[8:11], s38 offen nt lds
    s_add_u32 m0, s44, 17952
    s_mov_b32 s38, 115712
    buffer_load_dwordx4 v249, s[8:11], s38 offen nt lds
    s_add_u32 m0, s44, 19008
    s_mov_b32 s38, 116736
    buffer_load_dwordx4 v249, s[8:11], s38 offen nt lds
    s_add_u32 m0, s44, 20064
    s_mov_b32 s38, 117760
    buffer_load_dwordx4 v249, s[8:11], s38 offen nt lds
    v_mul_f32 v208, v208, v244
    v_mul_f32 v209, v209, v244
    v_mul_f32 v210, v210, v244
    v_mul_f32 v211, v211, v244
    v_mul_f32 v212, v212, v244
    v_mul_f32 v213, v213, v244
    v_mul_f32 v214, v214, v244
    v_mul_f32 v215, v215, v244
    v_cvt_pk_bf16_f32 v208, v208, v209
    v_cvt_pk_bf16_f32 v209, v210, v211
    v_cvt_pk_bf16_f32 v210, v212, v213
    v_cvt_pk_bf16_f32 v211, v214, v215
    ds_write_b128 v248, v[208:211]
    v_mul_f32 v216, v216, v244
    v_mul_f32 v217, v217, v244
    v_mul_f32 v218, v218, v244
    v_mul_f32 v219, v219, v244
    v_mul_f32 v220, v220, v244
    v_mul_f32 v221, v221, v244
    v_mul_f32 v222, v222, v244
    v_mul_f32 v223, v223, v244
    v_cvt_pk_bf16_f32 v216, v216, v217
    v_cvt_pk_bf16_f32 v217, v218, v219
    v_cvt_pk_bf16_f32 v218, v220, v221
    v_cvt_pk_bf16_f32 v219, v222, v223
    ds_write_b128 v254, v[216:219]
    v_mul_f32 v224, v224, v245
    v_mul_f32 v225, v225, v245
    v_mul_f32 v226, v226, v245
    v_mul_f32 v227, v227, v245
    v_mul_f32 v228, v228, v245
    v_mul_f32 v229, v229, v245
    v_mul_f32 v230, v230, v245
    v_mul_f32 v231, v231, v245
    v_cvt_pk_bf16_f32 v224, v224, v225
    v_cvt_pk_bf16_f32 v225, v226, v227
    v_cvt_pk_bf16_f32 v226, v228, v229
    v_cvt_pk_bf16_f32 v227, v230, v231
    ds_write_b128 v248, v[224:227] offset:2048
    v_mul_f32 v232, v232, v245
    v_mul_f32 v233, v233, v245
    v_mul_f32 v234, v234, v245
    v_mul_f32 v235, v235, v245
    v_mul_f32 v236, v236, v245
    v_mul_f32 v237, v237, v245
    v_mul_f32 v238, v238, v245
    v_mul_f32 v239, v239, v245
    v_cvt_pk_bf16_f32 v232, v232, v233
    v_cvt_pk_bf16_f32 v233, v234, v235
    v_cvt_pk_bf16_f32 v234, v236, v237
    v_cvt_pk_bf16_f32 v235, v238, v239
    ds_write_b128 v254, v[232:235] offset:2048
    ds_read_b128 v[212:215], v252
    ds_read_b128 v[220:223], v252 offset:1024
    ds_read_b128 v[228:231], v252 offset:2048
    ds_read_b128 v[236:239], v252 offset:3072
    ds_read_b128 v[204:207], v251
    ds_read_b128 v[192:195], v251 offset:256
    s_waitcnt lgkmcnt(1)
    v_add_f32 v204, v204, v205
    v_add_f32 v206, v206, v207
    v_add_f32 v204, v204, v206
    v_rcp_f32 v244, v204
    s_waitcnt lgkmcnt(0)
    v_add_f32 v192, v192, v193
    v_add_f32 v194, v194, v195
    v_add_f32 v192, v192, v194
    v_rcp_f32 v245, v192
    s_waitcnt lgkmcnt(0)
    s_barrier
    s_mov_b32 s14, 262144
    s_mov_b32 s43, s33
    s_add_u32 s33, s33, 16384
    v_mul_f32 v160, v160, v246
    v_mul_f32 v161, v161, v246
    v_mul_f32 v162, v162, v246
    v_mul_f32 v163, v163, v246
    v_mul_f32 v164, v164, v246
    v_mul_f32 v165, v165, v246
    v_mul_f32 v166, v166, v246
    v_mul_f32 v167, v167, v246
    v_cvt_pk_bf16_f32 v160, v160, v161
    v_cvt_pk_bf16_f32 v161, v162, v163
    v_cvt_pk_bf16_f32 v162, v164, v165
    v_cvt_pk_bf16_f32 v163, v166, v167
    ds_write_b128 v248, v[160:163]
    buffer_store_dwordx4 v[212:215], v253, s[12:15], s43 offen nt
    s_add_u32 s43, s43, 4096
    v_mul_f32 v168, v168, v246
    v_mul_f32 v169, v169, v246
    v_mul_f32 v170, v170, v246
    v_mul_f32 v171, v171, v246
    v_mul_f32 v172, v172, v246
    v_mul_f32 v173, v173, v246
    v_mul_f32 v174, v174, v246
    v_mul_f32 v175, v175, v246
    v_cvt_pk_bf16_f32 v168, v168, v169
    v_cvt_pk_bf16_f32 v169, v170, v171
    v_cvt_pk_bf16_f32 v170, v172, v173
    v_cvt_pk_bf16_f32 v171, v174, v175
    ds_write_b128 v254, v[168:171]
    buffer_store_dwordx4 v[220:223], v253, s[12:15], s43 offen nt
    s_add_u32 s43, s43, 4096
    v_mul_f32 v176, v176, v247
    v_mul_f32 v177, v177, v247
    v_mul_f32 v178, v178, v247
    v_mul_f32 v179, v179, v247
    v_mul_f32 v180, v180, v247
    v_mul_f32 v181, v181, v247
    v_mul_f32 v182, v182, v247
    v_mul_f32 v183, v183, v247
    v_cvt_pk_bf16_f32 v176, v176, v177
    v_cvt_pk_bf16_f32 v177, v178, v179
    v_cvt_pk_bf16_f32 v178, v180, v181
    v_cvt_pk_bf16_f32 v179, v182, v183
    ds_write_b128 v248, v[176:179] offset:2048
    buffer_store_dwordx4 v[228:231], v253, s[12:15], s43 offen nt
    s_add_u32 s43, s43, 4096
    v_mul_f32 v184, v184, v247
    v_mul_f32 v185, v185, v247
    v_mul_f32 v186, v186, v247
    v_mul_f32 v187, v187, v247
    v_mul_f32 v188, v188, v247
    v_mul_f32 v189, v189, v247
    v_mul_f32 v190, v190, v247
    v_mul_f32 v191, v191, v247
    v_cvt_pk_bf16_f32 v184, v184, v185
    v_cvt_pk_bf16_f32 v185, v186, v187
    v_cvt_pk_bf16_f32 v186, v188, v189
    v_cvt_pk_bf16_f32 v187, v190, v191
    ds_write_b128 v254, v[184:187] offset:2048
    buffer_store_dwordx4 v[236:239], v253, s[12:15], s43 offen nt
    ds_read_b128 v[164:167], v252
    ds_read_b128 v[172:175], v252 offset:1024
    ds_read_b128 v[180:183], v252 offset:2048
    ds_read_b128 v[188:191], v252 offset:3072
    s_mov_b32 s43, s33
    s_add_u32 s33, s33, 16384
    s_waitcnt lgkmcnt(3)
    buffer_store_dwordx4 v[164:167], v253, s[12:15], s43 offen nt
    s_add_u32 s43, s43, 4096
    s_waitcnt lgkmcnt(2)
    buffer_store_dwordx4 v[172:175], v253, s[12:15], s43 offen nt
    s_add_u32 s43, s43, 4096
    s_waitcnt lgkmcnt(1)
    buffer_store_dwordx4 v[180:183], v253, s[12:15], s43 offen nt
    s_add_u32 s43, s43, 4096
    s_waitcnt lgkmcnt(0)
    buffer_store_dwordx4 v[188:191], v253, s[12:15], s43 offen nt
    ds_read_b128 v[192:195], v250 offset:16384
    ds_read_b128 v[196:199], v250 offset:17408
    ds_read_b128 v[200:203], v250 offset:18432
    ds_read_b128 v[204:207], v250 offset:19456
    ds_read_b128 v[208:211], v250 offset:20480
    ds_read_b128 v[240:243], v251 offset:1024
    ds_read_b128 v[224:227], v251 offset:1280
    v_mul_f32 v128, v128, v244
    v_mul_f32 v129, v129, v244
    v_mul_f32 v130, v130, v244
    v_mul_f32 v131, v131, v244
    v_mul_f32 v132, v132, v244
    v_mul_f32 v133, v133, v244
    v_mul_f32 v134, v134, v244
    v_mul_f32 v135, v135, v244
    v_cvt_pk_bf16_f32 v128, v128, v129
    v_cvt_pk_bf16_f32 v129, v130, v131
    v_cvt_pk_bf16_f32 v130, v132, v133
    v_cvt_pk_bf16_f32 v131, v134, v135
    ds_write_b128 v248, v[128:131]
    s_cmp_lt_u32 s30, 262144
    s_cselect_b32 s10, 262144, 0
    s_cselect_b32 s42, s30, 0
    s_add_u32 s30, s30, 16384
    s_waitcnt lgkmcnt(7)
    v_mfma_f32_16x16x32_bf16 v[160:163], v[0:3], v[192:195], 0
    v_mul_f32 v136, v136, v244
    v_mul_f32 v137, v137, v244
    v_mfma_f32_16x16x32_bf16 v[164:167], v[32:35], v[192:195], 0
    v_mul_f32 v138, v138, v244
    v_mfma_f32_16x16x32_bf16 v[168:171], v[64:67], v[192:195], 0
    v_mul_f32 v139, v139, v244
    v_mul_f32 v140, v140, v244
    s_add_u32 m0, s31, 0
    s_nop 0
    buffer_load_dwordx4 v249, s[8:11], s42 offen nt lds
    v_mfma_f32_16x16x32_bf16 v[172:175], v[96:99], v[192:195], 0
    ds_read_b128 v[212:215], v250 offset:21504
    v_mul_f32 v141, v141, v244
    s_waitcnt lgkmcnt(7)
    v_mfma_f32_16x16x32_bf16 v[176:179], v[0:3], v[196:199], 0
    v_mul_f32 v142, v142, v244
    v_mul_f32 v143, v143, v244
    v_mfma_f32_16x16x32_bf16 v[180:183], v[32:35], v[196:199], 0
    v_cvt_pk_bf16_f32 v136, v136, v137
    v_mfma_f32_16x16x32_bf16 v[184:187], v[64:67], v[196:199], 0
    v_cvt_pk_bf16_f32 v137, v138, v139
    v_cvt_pk_bf16_f32 v138, v140, v141
    v_mfma_f32_16x16x32_bf16 v[188:191], v[96:99], v[196:199], 0
    ds_read_b128 v[216:219], v250 offset:22528
    v_cvt_pk_bf16_f32 v139, v142, v143
    s_waitcnt lgkmcnt(7)
    v_mfma_f32_16x16x32_bf16 v[160:163], v[4:7], v[200:203], v[160:163]
    ds_write_b128 v254, v[136:139]
    v_mul_f32 v144, v144, v245
    s_add_u32 m0, s31, 1056
    s_add_u32 s42, s42, 1024
    buffer_load_dwordx4 v249, s[8:11], s42 offen nt lds
    v_mfma_f32_16x16x32_bf16 v[164:167], v[36:39], v[200:203], v[164:167]
    v_mul_f32 v145, v145, v245
    v_mfma_f32_16x16x32_bf16 v[168:171], v[68:71], v[200:203], v[168:171]
    v_mul_f32 v146, v146, v245
    v_mul_f32 v147, v147, v245
    v_mfma_f32_16x16x32_bf16 v[172:175], v[100:103], v[200:203], v[172:175]
    ds_read_b128 v[220:223], v250 offset:23552
    v_mul_f32 v148, v148, v245
    s_waitcnt lgkmcnt(8)
    v_mfma_f32_16x16x32_bf16 v[176:179], v[4:7], v[204:207], v[176:179]
    v_mul_f32 v149, v149, v245
    v_mul_f32 v150, v150, v245
    v_mfma_f32_16x16x32_bf16 v[180:183], v[36:39], v[204:207], v[180:183]
    v_mul_f32 v151, v151, v245
    v_mfma_f32_16x16x32_bf16 v[184:187], v[68:71], v[204:207], v[184:187]
    v_cvt_pk_bf16_f32 v144, v144, v145
    v_cvt_pk_bf16_f32 v145, v146, v147
    s_add_u32 m0, s31, 2112
    s_add_u32 s42, s42, 1024
    buffer_load_dwordx4 v249, s[8:11], s42 offen nt lds
    v_mfma_f32_16x16x32_bf16 v[188:191], v[100:103], v[204:207], v[188:191]
    ds_read_b128 v[192:195], v250 offset:24576
    v_cvt_pk_bf16_f32 v146, v148, v149
    s_waitcnt lgkmcnt(8)
    v_mfma_f32_16x16x32_bf16 v[160:163], v[8:11], v[208:211], v[160:163]
    v_cvt_pk_bf16_f32 v147, v150, v151
    ds_write_b128 v248, v[144:147] offset:2048
    v_mfma_f32_16x16x32_bf16 v[164:167], v[40:43], v[208:211], v[164:167]
    v_mul_f32 v152, v152, v245
    v_mfma_f32_16x16x32_bf16 v[168:171], v[72:75], v[208:211], v[168:171]
    v_mul_f32 v153, v153, v245
    v_mul_f32 v154, v154, v245
    v_mfma_f32_16x16x32_bf16 v[172:175], v[104:107], v[208:211], v[172:175]
    ds_read_b128 v[196:199], v250 offset:25600
    v_mul_f32 v155, v155, v245
    s_waitcnt lgkmcnt(6)
    v_mfma_f32_16x16x32_bf16 v[176:179], v[8:11], v[212:215], v[176:179]
    v_mul_f32 v156, v156, v245
    v_mul_f32 v157, v157, v245
    s_add_u32 m0, s31, 3168
    s_add_u32 s42, s42, 1024
    buffer_load_dwordx4 v249, s[8:11], s42 offen nt lds
    v_mfma_f32_16x16x32_bf16 v[180:183], v[40:43], v[212:215], v[180:183]
    v_mul_f32 v158, v158, v245
    v_mfma_f32_16x16x32_bf16 v[184:187], v[72:75], v[212:215], v[184:187]
    v_mul_f32 v159, v159, v245
    v_cvt_pk_bf16_f32 v152, v152, v153
    s_add_u32 s31, s31, 16896
    s_cmp_eq_u32 s31, s45
    s_cselect_b32 s31, s44, s31
    v_mfma_f32_16x16x32_bf16 v[188:191], v[104:107], v[212:215], v[188:191]
    ds_read_b128 v[200:203], v250 offset:26624
    v_cvt_pk_bf16_f32 v153, v154, v155
    s_waitcnt lgkmcnt(6)
    v_mfma_f32_16x16x32_bf16 v[160:163], v[12:15], v[216:219], v[160:163]
    v_cvt_pk_bf16_f32 v154, v156, v157
    v_cvt_pk_bf16_f32 v155, v158, v159
    v_mfma_f32_16x16x32_bf16 v[164:167], v[44:47], v[216:219], v[164:167]
    ds_write_b128 v254, v[152:155] offset:2048
    v_mfma_f32_16x16x32_bf16 v[168:171], v[76:79], v[216:219], v[168:171]
    v_add_f32 v240, v240, v241
    v_add_f32 v242, v242, v243
    v_add_f32 v240, v240, v242
    v_rcp_f32 v246, v240
    v_add_f32 v224, v224, v225
    v_add_f32 v226, v226, v227
    v_add_f32 v224, v224, v226
    v_rcp_f32 v247, v224
    v_mfma_f32_16x16x32_bf16 v[172:175], v[108:111], v[216:219], v[172:175]
    ds_read_b128 v[204:207], v250 offset:27648
    s_waitcnt lgkmcnt(6)
    v_mfma_f32_16x16x32_bf16 v[176:179], v[12:15], v[220:223], v[176:179]
    ds_read_b128 v[132:135], v252
    ds_read_b128 v[140:143], v252 offset:1024
    v_mfma_f32_16x16x32_bf16 v[180:183], v[44:47], v[220:223], v[180:183]
    v_mfma_f32_16x16x32_bf16 v[184:187], v[76:79], v[220:223], v[184:187]
    ds_read_b128 v[148:151], v252 offset:2048
    ds_read_b128 v[156:159], v252 offset:3072
    s_mov_b32 s43, s33
    s_add_u32 s33, s33, 16384
    v_mfma_f32_16x16x32_bf16 v[188:191], v[108:111], v[220:223], v[188:191]
    ds_read_b128 v[208:211], v250 offset:28672
    s_waitcnt lgkmcnt(10)
    v_mfma_f32_16x16x32_bf16 v[160:163], v[16:19], v[192:195], v[160:163]
    v_mfma_f32_16x16x32_bf16 v[164:167], v[48:51], v[192:195], v[164:167]
    v_mfma_f32_16x16x32_bf16 v[168:171], v[80:83], v[192:195], v[168:171]
    v_mfma_f32_16x16x32_bf16 v[172:175], v[112:115], v[192:195], v[172:175]
    ds_read_b128 v[212:215], v250 offset:29696
    s_waitcnt lgkmcnt(9)
    v_mfma_f32_16x16x32_bf16 v[176:179], v[16:19], v[196:199], v[176:179]
    s_waitcnt lgkmcnt(5)
    buffer_store_dwordx4 v[132:135], v253, s[12:15], s43 offen nt
    s_add_u32 s43, s43, 4096
    v_mfma_f32_16x16x32_bf16 v[180:183], v[48:51], v[196:199], v[180:183]
    v_mfma_f32_16x16x32_bf16 v[184:187], v[80:83], v[196:199], v[184:187]
    v_mfma_f32_16x16x32_bf16 v[188:191], v[112:115], v[196:199], v[188:191]
    ds_read_b128 v[216:219], v250 offset:30720
    v_mfma_f32_16x16x32_bf16 v[160:163], v[20:23], v[200:203], v[160:163]
    v_mfma_f32_16x16x32_bf16 v[164:167], v[52:55], v[200:203], v[164:167]
    v_mfma_f32_16x16x32_bf16 v[168:171], v[84:87], v[200:203], v[168:171]
    s_waitcnt lgkmcnt(5)
    buffer_store_dwordx4 v[140:143], v253, s[12:15], s43 offen nt
    s_add_u32 s43, s43, 4096
    v_mfma_f32_16x16x32_bf16 v[172:175], v[116:119], v[200:203], v[172:175]
    ds_read_b128 v[220:223], v250 offset:31744
    v_mfma_f32_16x16x32_bf16 v[176:179], v[20:23], v[204:207], v[176:179]
    v_mfma_f32_16x16x32_bf16 v[180:183], v[52:55], v[204:207], v[180:183]
    v_mfma_f32_16x16x32_bf16 v[184:187], v[84:87], v[204:207], v[184:187]
    v_mfma_f32_16x16x32_bf16 v[188:191], v[116:119], v[204:207], v[188:191]
    s_waitcnt lgkmcnt(3)
    v_mfma_f32_16x16x32_bf16 v[160:163], v[24:27], v[208:211], v[160:163]
    buffer_store_dwordx4 v[148:151], v253, s[12:15], s43 offen nt
    s_add_u32 s43, s43, 4096
    v_mfma_f32_16x16x32_bf16 v[164:167], v[56:59], v[208:211], v[164:167]
    v_mfma_f32_16x16x32_bf16 v[168:171], v[88:91], v[208:211], v[168:171]
    v_mfma_f32_16x16x32_bf16 v[172:175], v[120:123], v[208:211], v[172:175]
    s_waitcnt lgkmcnt(2)
    v_mfma_f32_16x16x32_bf16 v[176:179], v[24:27], v[212:215], v[176:179]
    v_mfma_f32_16x16x32_bf16 v[180:183], v[56:59], v[212:215], v[180:183]
    v_mfma_f32_16x16x32_bf16 v[184:187], v[88:91], v[212:215], v[184:187]
    buffer_store_dwordx4 v[156:159], v253, s[12:15], s43 offen nt
    v_mfma_f32_16x16x32_bf16 v[188:191], v[120:123], v[212:215], v[188:191]
    s_waitcnt lgkmcnt(1)
    v_mfma_f32_16x16x32_bf16 v[160:163], v[28:31], v[216:219], v[160:163]
    v_mfma_f32_16x16x32_bf16 v[164:167], v[60:63], v[216:219], v[164:167]
    v_mfma_f32_16x16x32_bf16 v[168:171], v[92:95], v[216:219], v[168:171]
    v_mfma_f32_16x16x32_bf16 v[172:175], v[124:127], v[216:219], v[172:175]
    s_waitcnt lgkmcnt(0)
    v_mfma_f32_16x16x32_bf16 v[176:179], v[28:31], v[220:223], v[176:179]
    v_mfma_f32_16x16x32_bf16 v[180:183], v[60:63], v[220:223], v[180:183]
    v_mfma_f32_16x16x32_bf16 v[184:187], v[92:95], v[220:223], v[184:187]
    v_mfma_f32_16x16x32_bf16 v[188:191], v[124:127], v[220:223], v[188:191]
    s_waitcnt vmcnt(16)
    s_barrier
    s_add_u32 s34, s34, 1
.p2align 6
L_pv_loop:
    ds_read_b128 v[192:195], v250
    ds_read_b128 v[196:199], v250 offset:1024
    ds_read_b128 v[200:203], v250 offset:2048
    ds_read_b128 v[204:207], v250 offset:3072
    ds_read_b128 v[208:211], v250 offset:4096
    ds_read_b128 v[240:243], v251
    ds_read_b128 v[224:227], v251 offset:256
    v_mul_f32 v160, v160, v246
    v_mul_f32 v161, v161, v246
    v_mul_f32 v162, v162, v246
    v_mul_f32 v163, v163, v246
    v_mul_f32 v164, v164, v246
    v_mul_f32 v165, v165, v246
    v_mul_f32 v166, v166, v246
    v_mul_f32 v167, v167, v246
    v_cvt_pk_bf16_f32 v160, v160, v161
    v_cvt_pk_bf16_f32 v161, v162, v163
    v_cvt_pk_bf16_f32 v162, v164, v165
    v_cvt_pk_bf16_f32 v163, v166, v167
    ds_write_b128 v248, v[160:163]
    v_mul_f32 v168, v168, v246
    v_mul_f32 v169, v169, v246
    v_mul_f32 v170, v170, v246
    v_mul_f32 v171, v171, v246
    v_mul_f32 v172, v172, v246
    v_mul_f32 v173, v173, v246
    v_mul_f32 v174, v174, v246
    v_mul_f32 v175, v175, v246
    v_cvt_pk_bf16_f32 v168, v168, v169
    v_cvt_pk_bf16_f32 v169, v170, v171
    v_cvt_pk_bf16_f32 v170, v172, v173
    v_cvt_pk_bf16_f32 v171, v174, v175
    ds_write_b128 v254, v[168:171]
    s_cmp_gt_u32 s34, 10
    s_cbranch_scc1 L_pv_nq1
    s_mov_b32 s42, s30
    s_add_u32 s30, s30, 16384
    s_add_u32 m0, s31, 0
    s_nop 0
    buffer_load_dwordx4 v249, s[8:11], s42 offen nt lds
    s_add_u32 m0, s31, 1056
    s_add_u32 s42, s42, 1024
    buffer_load_dwordx4 v249, s[8:11], s42 offen nt lds
    s_add_u32 m0, s31, 2112
    s_add_u32 s42, s42, 1024
    buffer_load_dwordx4 v249, s[8:11], s42 offen nt lds
    s_add_u32 m0, s31, 3168
    s_add_u32 s42, s42, 1024
    buffer_load_dwordx4 v249, s[8:11], s42 offen nt lds
    s_add_u32 s31, s31, 16896
    s_cmp_eq_u32 s31, s45
    s_cselect_b32 s31, s44, s31
L_pv_nq1:
    v_mul_f32 v176, v176, v247
    v_mul_f32 v177, v177, v247
    v_mul_f32 v178, v178, v247
    v_mul_f32 v179, v179, v247
    v_mul_f32 v180, v180, v247
    v_mul_f32 v181, v181, v247
    v_mul_f32 v182, v182, v247
    v_mul_f32 v183, v183, v247
    v_cvt_pk_bf16_f32 v176, v176, v177
    v_cvt_pk_bf16_f32 v177, v178, v179
    v_cvt_pk_bf16_f32 v178, v180, v181
    v_cvt_pk_bf16_f32 v179, v182, v183
    ds_write_b128 v248, v[176:179] offset:2048
    v_mul_f32 v184, v184, v247
    v_mul_f32 v185, v185, v247
    v_mul_f32 v186, v186, v247
    v_mul_f32 v187, v187, v247
    v_mul_f32 v188, v188, v247
    v_mul_f32 v189, v189, v247
    v_mul_f32 v190, v190, v247
    v_mul_f32 v191, v191, v247
    v_cvt_pk_bf16_f32 v184, v184, v185
    v_cvt_pk_bf16_f32 v185, v186, v187
    v_cvt_pk_bf16_f32 v186, v188, v189
    v_cvt_pk_bf16_f32 v187, v190, v191
    ds_write_b128 v254, v[184:187] offset:2048
    ds_read_b128 v[164:167], v252
    ds_read_b128 v[172:175], v252 offset:1024
    ds_read_b128 v[180:183], v252 offset:2048
    ds_read_b128 v[188:191], v252 offset:3072
    s_waitcnt lgkmcnt(9)
    v_add_f32 v240, v240, v241
    v_add_f32 v242, v242, v243
    v_add_f32 v240, v240, v242
    v_rcp_f32 v244, v240
    s_waitcnt lgkmcnt(8)
    v_add_f32 v224, v224, v225
    v_add_f32 v226, v226, v227
    v_add_f32 v224, v224, v226
    v_rcp_f32 v245, v224
    s_mov_b32 s43, s33
    s_add_u32 s33, s33, 16384
    s_waitcnt lgkmcnt(3)
    buffer_store_dwordx4 v[164:167], v253, s[12:15], s43 offen nt
    s_add_u32 s43, s43, 4096
    s_waitcnt lgkmcnt(2)
    buffer_store_dwordx4 v[172:175], v253, s[12:15], s43 offen nt
    s_add_u32 s43, s43, 4096
    s_waitcnt lgkmcnt(1)
    buffer_store_dwordx4 v[180:183], v253, s[12:15], s43 offen nt
    s_add_u32 s43, s43, 4096
    s_waitcnt lgkmcnt(0)
    buffer_store_dwordx4 v[188:191], v253, s[12:15], s43 offen nt
    v_mfma_f32_16x16x32_bf16 v[128:131], v[0:3], v[192:195], 0
    v_mfma_f32_16x16x32_bf16 v[132:135], v[32:35], v[192:195], 0
    v_mfma_f32_16x16x32_bf16 v[136:139], v[64:67], v[192:195], 0
    v_mfma_f32_16x16x32_bf16 v[140:143], v[96:99], v[192:195], 0
    ds_read_b128 v[212:215], v250 offset:5120
    v_mfma_f32_16x16x32_bf16 v[144:147], v[0:3], v[196:199], 0
    v_mfma_f32_16x16x32_bf16 v[148:151], v[32:35], v[196:199], 0
    v_mfma_f32_16x16x32_bf16 v[152:155], v[64:67], v[196:199], 0
    v_mfma_f32_16x16x32_bf16 v[156:159], v[96:99], v[196:199], 0
    ds_read_b128 v[216:219], v250 offset:6144
    v_mfma_f32_16x16x32_bf16 v[128:131], v[4:7], v[200:203], v[128:131]
    v_mfma_f32_16x16x32_bf16 v[132:135], v[36:39], v[200:203], v[132:135]
    v_mfma_f32_16x16x32_bf16 v[136:139], v[68:71], v[200:203], v[136:139]
    v_mfma_f32_16x16x32_bf16 v[140:143], v[100:103], v[200:203], v[140:143]
    ds_read_b128 v[220:223], v250 offset:7168
    v_mfma_f32_16x16x32_bf16 v[144:147], v[4:7], v[204:207], v[144:147]
    v_mfma_f32_16x16x32_bf16 v[148:151], v[36:39], v[204:207], v[148:151]
    v_mfma_f32_16x16x32_bf16 v[152:155], v[68:71], v[204:207], v[152:155]
    v_mfma_f32_16x16x32_bf16 v[156:159], v[100:103], v[204:207], v[156:159]
    ds_read_b128 v[192:195], v250 offset:8192
    v_mfma_f32_16x16x32_bf16 v[128:131], v[8:11], v[208:211], v[128:131]
    v_mfma_f32_16x16x32_bf16 v[132:135], v[40:43], v[208:211], v[132:135]
    v_mfma_f32_16x16x32_bf16 v[136:139], v[72:75], v[208:211], v[136:139]
    v_mfma_f32_16x16x32_bf16 v[140:143], v[104:107], v[208:211], v[140:143]
    ds_read_b128 v[196:199], v250 offset:9216
    s_waitcnt lgkmcnt(4)
    v_mfma_f32_16x16x32_bf16 v[144:147], v[8:11], v[212:215], v[144:147]
    v_mfma_f32_16x16x32_bf16 v[148:151], v[40:43], v[212:215], v[148:151]
    v_mfma_f32_16x16x32_bf16 v[152:155], v[72:75], v[212:215], v[152:155]
    v_mfma_f32_16x16x32_bf16 v[156:159], v[104:107], v[212:215], v[156:159]
    ds_read_b128 v[200:203], v250 offset:10240
    s_waitcnt lgkmcnt(4)
    v_mfma_f32_16x16x32_bf16 v[128:131], v[12:15], v[216:219], v[128:131]
    v_mfma_f32_16x16x32_bf16 v[132:135], v[44:47], v[216:219], v[132:135]
    v_mfma_f32_16x16x32_bf16 v[136:139], v[76:79], v[216:219], v[136:139]
    v_mfma_f32_16x16x32_bf16 v[140:143], v[108:111], v[216:219], v[140:143]
    ds_read_b128 v[204:207], v250 offset:11264
    s_waitcnt lgkmcnt(4)
    v_mfma_f32_16x16x32_bf16 v[144:147], v[12:15], v[220:223], v[144:147]
    v_mfma_f32_16x16x32_bf16 v[148:151], v[44:47], v[220:223], v[148:151]
    v_mfma_f32_16x16x32_bf16 v[152:155], v[76:79], v[220:223], v[152:155]
    v_mfma_f32_16x16x32_bf16 v[156:159], v[108:111], v[220:223], v[156:159]
    ds_read_b128 v[208:211], v250 offset:12288
    s_waitcnt lgkmcnt(4)
    v_mfma_f32_16x16x32_bf16 v[128:131], v[16:19], v[192:195], v[128:131]
    v_mfma_f32_16x16x32_bf16 v[132:135], v[48:51], v[192:195], v[132:135]
    v_mfma_f32_16x16x32_bf16 v[136:139], v[80:83], v[192:195], v[136:139]
    v_mfma_f32_16x16x32_bf16 v[140:143], v[112:115], v[192:195], v[140:143]
    ds_read_b128 v[212:215], v250 offset:13312
    s_waitcnt lgkmcnt(4)
    v_mfma_f32_16x16x32_bf16 v[144:147], v[16:19], v[196:199], v[144:147]
    v_mfma_f32_16x16x32_bf16 v[148:151], v[48:51], v[196:199], v[148:151]
    v_mfma_f32_16x16x32_bf16 v[152:155], v[80:83], v[196:199], v[152:155]
    v_mfma_f32_16x16x32_bf16 v[156:159], v[112:115], v[196:199], v[156:159]
    ds_read_b128 v[216:219], v250 offset:14336
    s_waitcnt lgkmcnt(4)
    v_mfma_f32_16x16x32_bf16 v[128:131], v[20:23], v[200:203], v[128:131]
    v_mfma_f32_16x16x32_bf16 v[132:135], v[52:55], v[200:203], v[132:135]
    v_mfma_f32_16x16x32_bf16 v[136:139], v[84:87], v[200:203], v[136:139]
    v_mfma_f32_16x16x32_bf16 v[140:143], v[116:119], v[200:203], v[140:143]
    ds_read_b128 v[220:223], v250 offset:15360
    s_waitcnt lgkmcnt(4)
    v_mfma_f32_16x16x32_bf16 v[144:147], v[20:23], v[204:207], v[144:147]
    v_mfma_f32_16x16x32_bf16 v[148:151], v[52:55], v[204:207], v[148:151]
    v_mfma_f32_16x16x32_bf16 v[152:155], v[84:87], v[204:207], v[152:155]
    v_mfma_f32_16x16x32_bf16 v[156:159], v[116:119], v[204:207], v[156:159]
    s_waitcnt lgkmcnt(3)
    v_mfma_f32_16x16x32_bf16 v[128:131], v[24:27], v[208:211], v[128:131]
    v_mfma_f32_16x16x32_bf16 v[132:135], v[56:59], v[208:211], v[132:135]
    v_mfma_f32_16x16x32_bf16 v[136:139], v[88:91], v[208:211], v[136:139]
    v_mfma_f32_16x16x32_bf16 v[140:143], v[120:123], v[208:211], v[140:143]
    s_waitcnt lgkmcnt(2)
    v_mfma_f32_16x16x32_bf16 v[144:147], v[24:27], v[212:215], v[144:147]
    v_mfma_f32_16x16x32_bf16 v[148:151], v[56:59], v[212:215], v[148:151]
    v_mfma_f32_16x16x32_bf16 v[152:155], v[88:91], v[212:215], v[152:155]
    v_mfma_f32_16x16x32_bf16 v[156:159], v[120:123], v[212:215], v[156:159]
    s_waitcnt lgkmcnt(1)
    v_mfma_f32_16x16x32_bf16 v[128:131], v[28:31], v[216:219], v[128:131]
    v_mfma_f32_16x16x32_bf16 v[132:135], v[60:63], v[216:219], v[132:135]
    v_mfma_f32_16x16x32_bf16 v[136:139], v[92:95], v[216:219], v[136:139]
    v_mfma_f32_16x16x32_bf16 v[140:143], v[124:127], v[216:219], v[140:143]
    s_waitcnt lgkmcnt(0)
    v_mfma_f32_16x16x32_bf16 v[144:147], v[28:31], v[220:223], v[144:147]
    v_mfma_f32_16x16x32_bf16 v[148:151], v[60:63], v[220:223], v[148:151]
    v_mfma_f32_16x16x32_bf16 v[152:155], v[92:95], v[220:223], v[152:155]
    v_mfma_f32_16x16x32_bf16 v[156:159], v[124:127], v[220:223], v[156:159]
    s_waitcnt vmcnt(28)
    s_sub_u32 s53, s34, 6
    s_cmp_lt_u32 s53, 5
    s_cbranch_scc1 L_pv_w1
    s_waitcnt vmcnt(16)
L_pv_w1:
    s_barrier
    s_add_u32 s34, s34, 1
    ds_read_b128 v[192:195], v250 offset:16384
    ds_read_b128 v[196:199], v250 offset:17408
    ds_read_b128 v[200:203], v250 offset:18432
    ds_read_b128 v[204:207], v250 offset:19456
    ds_read_b128 v[208:211], v250 offset:20480
    ds_read_b128 v[240:243], v251 offset:1024
    ds_read_b128 v[224:227], v251 offset:1280
    v_mul_f32 v128, v128, v244
    v_mul_f32 v129, v129, v244
    v_mul_f32 v130, v130, v244
    v_mul_f32 v131, v131, v244
    v_mul_f32 v132, v132, v244
    v_mul_f32 v133, v133, v244
    v_mul_f32 v134, v134, v244
    v_mul_f32 v135, v135, v244
    v_cvt_pk_bf16_f32 v128, v128, v129
    v_cvt_pk_bf16_f32 v129, v130, v131
    v_cvt_pk_bf16_f32 v130, v132, v133
    v_cvt_pk_bf16_f32 v131, v134, v135
    ds_write_b128 v248, v[128:131]
    v_mul_f32 v136, v136, v244
    v_mul_f32 v137, v137, v244
    v_mul_f32 v138, v138, v244
    v_mul_f32 v139, v139, v244
    v_mul_f32 v140, v140, v244
    v_mul_f32 v141, v141, v244
    v_mul_f32 v142, v142, v244
    v_mul_f32 v143, v143, v244
    v_cvt_pk_bf16_f32 v136, v136, v137
    v_cvt_pk_bf16_f32 v137, v138, v139
    v_cvt_pk_bf16_f32 v138, v140, v141
    v_cvt_pk_bf16_f32 v139, v142, v143
    ds_write_b128 v254, v[136:139]
    s_cmp_gt_u32 s34, 10
    s_cbranch_scc1 L_pv_nq0
    s_mov_b32 s42, s30
    s_add_u32 s30, s30, 16384
    s_add_u32 m0, s31, 0
    s_nop 0
    buffer_load_dwordx4 v249, s[8:11], s42 offen nt lds
    s_add_u32 m0, s31, 1056
    s_add_u32 s42, s42, 1024
    buffer_load_dwordx4 v249, s[8:11], s42 offen nt lds
    s_add_u32 m0, s31, 2112
    s_add_u32 s42, s42, 1024
    buffer_load_dwordx4 v249, s[8:11], s42 offen nt lds
    s_add_u32 m0, s31, 3168
    s_add_u32 s42, s42, 1024
    buffer_load_dwordx4 v249, s[8:11], s42 offen nt lds
    s_add_u32 s31, s31, 16896
    s_cmp_eq_u32 s31, s45
    s_cselect_b32 s31, s44, s31
L_pv_nq0:
    v_mul_f32 v144, v144, v245
    v_mul_f32 v145, v145, v245
    v_mul_f32 v146, v146, v245
    v_mul_f32 v147, v147, v245
    v_mul_f32 v148, v148, v245
    v_mul_f32 v149, v149, v245
    v_mul_f32 v150, v150, v245
    v_mul_f32 v151, v151, v245
    v_cvt_pk_bf16_f32 v144, v144, v145
    v_cvt_pk_bf16_f32 v145, v146, v147
    v_cvt_pk_bf16_f32 v146, v148, v149
    v_cvt_pk_bf16_f32 v147, v150, v151
    ds_write_b128 v248, v[144:147] offset:2048
    v_mul_f32 v152, v152, v245
    v_mul_f32 v153, v153, v245
    v_mul_f32 v154, v154, v245
    v_mul_f32 v155, v155, v245
    v_mul_f32 v156, v156, v245
    v_mul_f32 v157, v157, v245
    v_mul_f32 v158, v158, v245
    v_mul_f32 v159, v159, v245
    v_cvt_pk_bf16_f32 v152, v152, v153
    v_cvt_pk_bf16_f32 v153, v154, v155
    v_cvt_pk_bf16_f32 v154, v156, v157
    v_cvt_pk_bf16_f32 v155, v158, v159
    ds_write_b128 v254, v[152:155] offset:2048
    ds_read_b128 v[132:135], v252
    ds_read_b128 v[140:143], v252 offset:1024
    ds_read_b128 v[148:151], v252 offset:2048
    ds_read_b128 v[156:159], v252 offset:3072
    s_waitcnt lgkmcnt(9)
    v_add_f32 v240, v240, v241
    v_add_f32 v242, v242, v243
    v_add_f32 v240, v240, v242
    v_rcp_f32 v246, v240
    s_waitcnt lgkmcnt(8)
    v_add_f32 v224, v224, v225
    v_add_f32 v226, v226, v227
    v_add_f32 v224, v224, v226
    v_rcp_f32 v247, v224
    s_mov_b32 s43, s33
    s_add_u32 s33, s33, 16384
    s_waitcnt lgkmcnt(3)
    buffer_store_dwordx4 v[132:135], v253, s[12:15], s43 offen nt
    s_add_u32 s43, s43, 4096
    s_waitcnt lgkmcnt(2)
    buffer_store_dwordx4 v[140:143], v253, s[12:15], s43 offen nt
    s_add_u32 s43, s43, 4096
    s_waitcnt lgkmcnt(1)
    buffer_store_dwordx4 v[148:151], v253, s[12:15], s43 offen nt
    s_add_u32 s43, s43, 4096
    s_waitcnt lgkmcnt(0)
    buffer_store_dwordx4 v[156:159], v253, s[12:15], s43 offen nt
    v_mfma_f32_16x16x32_bf16 v[160:163], v[0:3], v[192:195], 0
    v_mfma_f32_16x16x32_bf16 v[164:167], v[32:35], v[192:195], 0
    v_mfma_f32_16x16x32_bf16 v[168:171], v[64:67], v[192:195], 0
    v_mfma_f32_16x16x32_bf16 v[172:175], v[96:99], v[192:195], 0
    ds_read_b128 v[212:215], v250 offset:21504
    v_mfma_f32_16x16x32_bf16 v[176:179], v[0:3], v[196:199], 0
    v_mfma_f32_16x16x32_bf16 v[180:183], v[32:35], v[196:199], 0
    v_mfma_f32_16x16x32_bf16 v[184:187], v[64:67], v[196:199], 0
    v_mfma_f32_16x16x32_bf16 v[188:191], v[96:99], v[196:199], 0
    ds_read_b128 v[216:219], v250 offset:22528
    v_mfma_f32_16x16x32_bf16 v[160:163], v[4:7], v[200:203], v[160:163]
    v_mfma_f32_16x16x32_bf16 v[164:167], v[36:39], v[200:203], v[164:167]
    v_mfma_f32_16x16x32_bf16 v[168:171], v[68:71], v[200:203], v[168:171]
    v_mfma_f32_16x16x32_bf16 v[172:175], v[100:103], v[200:203], v[172:175]
    ds_read_b128 v[220:223], v250 offset:23552
    v_mfma_f32_16x16x32_bf16 v[176:179], v[4:7], v[204:207], v[176:179]
    v_mfma_f32_16x16x32_bf16 v[180:183], v[36:39], v[204:207], v[180:183]
    v_mfma_f32_16x16x32_bf16 v[184:187], v[68:71], v[204:207], v[184:187]
    v_mfma_f32_16x16x32_bf16 v[188:191], v[100:103], v[204:207], v[188:191]
    ds_read_b128 v[192:195], v250 offset:24576
    v_mfma_f32_16x16x32_bf16 v[160:163], v[8:11], v[208:211], v[160:163]
    v_mfma_f32_16x16x32_bf16 v[164:167], v[40:43], v[208:211], v[164:167]
    v_mfma_f32_16x16x32_bf16 v[168:171], v[72:75], v[208:211], v[168:171]
    v_mfma_f32_16x16x32_bf16 v[172:175], v[104:107], v[208:211], v[172:175]
    ds_read_b128 v[196:199], v250 offset:25600
    s_waitcnt lgkmcnt(4)
    v_mfma_f32_16x16x32_bf16 v[176:179], v[8:11], v[212:215], v[176:179]
    v_mfma_f32_16x16x32_bf16 v[180:183], v[40:43], v[212:215], v[180:183]
    v_mfma_f32_16x16x32_bf16 v[184:187], v[72:75], v[212:215], v[184:187]
    v_mfma_f32_16x16x32_bf16 v[188:191], v[104:107], v[212:215], v[188:191]
    ds_read_b128 v[200:203], v250 offset:26624
    s_waitcnt lgkmcnt(4)
    v_mfma_f32_16x16x32_bf16 v[160:163], v[12:15], v[216:219], v[160:163]
    v_mfma_f32_16x16x32_bf16 v[164:167], v[44:47], v[216:219], v[164:167]
    v_mfma_f32_16x16x32_bf16 v[168:171], v[76:79], v[216:219], v[168:171]
    v_mfma_f32_16x16x32_bf16 v[172:175], v[108:111], v[216:219], v[172:175]
    ds_read_b128 v[204:207], v250 offset:27648
    s_waitcnt lgkmcnt(4)
    v_mfma_f32_16x16x32_bf16 v[176:179], v[12:15], v[220:223], v[176:179]
    v_mfma_f32_16x16x32_bf16 v[180:183], v[44:47], v[220:223], v[180:183]
    v_mfma_f32_16x16x32_bf16 v[184:187], v[76:79], v[220:223], v[184:187]
    v_mfma_f32_16x16x32_bf16 v[188:191], v[108:111], v[220:223], v[188:191]
    ds_read_b128 v[208:211], v250 offset:28672
    s_waitcnt lgkmcnt(4)
    v_mfma_f32_16x16x32_bf16 v[160:163], v[16:19], v[192:195], v[160:163]
    v_mfma_f32_16x16x32_bf16 v[164:167], v[48:51], v[192:195], v[164:167]
    v_mfma_f32_16x16x32_bf16 v[168:171], v[80:83], v[192:195], v[168:171]
    v_mfma_f32_16x16x32_bf16 v[172:175], v[112:115], v[192:195], v[172:175]
    ds_read_b128 v[212:215], v250 offset:29696
    s_waitcnt lgkmcnt(4)
    v_mfma_f32_16x16x32_bf16 v[176:179], v[16:19], v[196:199], v[176:179]
    v_mfma_f32_16x16x32_bf16 v[180:183], v[48:51], v[196:199], v[180:183]
    v_mfma_f32_16x16x32_bf16 v[184:187], v[80:83], v[196:199], v[184:187]
    v_mfma_f32_16x16x32_bf16 v[188:191], v[112:115], v[196:199], v[188:191]
    ds_read_b128 v[216:219], v250 offset:30720
    s_waitcnt lgkmcnt(4)
    v_mfma_f32_16x16x32_bf16 v[160:163], v[20:23], v[200:203], v[160:163]
    v_mfma_f32_16x16x32_bf16 v[164:167], v[52:55], v[200:203], v[164:167]
    v_mfma_f32_16x16x32_bf16 v[168:171], v[84:87], v[200:203], v[168:171]
    v_mfma_f32_16x16x32_bf16 v[172:175], v[116:119], v[200:203], v[172:175]
    ds_read_b128 v[220:223], v250 offset:31744
    s_waitcnt lgkmcnt(4)
    v_mfma_f32_16x16x32_bf16 v[176:179], v[20:23], v[204:207], v[176:179]
    v_mfma_f32_16x16x32_bf16 v[180:183], v[52:55], v[204:207], v[180:183]
    v_mfma_f32_16x16x32_bf16 v[184:187], v[84:87], v[204:207], v[184:187]
    v_mfma_f32_16x16x32_bf16 v[188:191], v[116:119], v[204:207], v[188:191]
    s_waitcnt lgkmcnt(3)
    v_mfma_f32_16x16x32_bf16 v[160:163], v[24:27], v[208:211], v[160:163]
    v_mfma_f32_16x16x32_bf16 v[164:167], v[56:59], v[208:211], v[164:167]
    v_mfma_f32_16x16x32_bf16 v[168:171], v[88:91], v[208:211], v[168:171]
    v_mfma_f32_16x16x32_bf16 v[172:175], v[120:123], v[208:211], v[172:175]
    s_waitcnt lgkmcnt(2)
    v_mfma_f32_16x16x32_bf16 v[176:179], v[24:27], v[212:215], v[176:179]
    v_mfma_f32_16x16x32_bf16 v[180:183], v[56:59], v[212:215], v[180:183]
    v_mfma_f32_16x16x32_bf16 v[184:187], v[88:91], v[212:215], v[184:187]
    v_mfma_f32_16x16x32_bf16 v[188:191], v[120:123], v[212:215], v[188:191]
    s_waitcnt lgkmcnt(1)
    v_mfma_f32_16x16x32_bf16 v[160:163], v[28:31], v[216:219], v[160:163]
    v_mfma_f32_16x16x32_bf16 v[164:167], v[60:63], v[216:219], v[164:167]
    v_mfma_f32_16x16x32_bf16 v[168:171], v[92:95], v[216:219], v[168:171]
    v_mfma_f32_16x16x32_bf16 v[172:175], v[124:127], v[216:219], v[172:175]
    s_waitcnt lgkmcnt(0)
    v_mfma_f32_16x16x32_bf16 v[176:179], v[28:31], v[220:223], v[176:179]
    v_mfma_f32_16x16x32_bf16 v[180:183], v[60:63], v[220:223], v[180:183]
    v_mfma_f32_16x16x32_bf16 v[184:187], v[92:95], v[220:223], v[184:187]
    v_mfma_f32_16x16x32_bf16 v[188:191], v[124:127], v[220:223], v[188:191]
    s_waitcnt vmcnt(28)
    s_sub_u32 s53, s34, 6
    s_cmp_lt_u32 s53, 5
    s_cbranch_scc1 L_pv_w0
    s_waitcnt vmcnt(16)
L_pv_w0:
    s_barrier
    s_add_u32 s34, s34, 1
    s_cmp_lt_u32 s34, 16
    s_cbranch_scc1 L_pv_loop
L_pv_tail:
    s_nop 7
    s_nop 7
    s_setprio 2
    ds_read_b128 v[192:195], v250
    ds_read_b128 v[196:199], v250 offset:1024
    ds_read_b128 v[200:203], v250 offset:2048
    ds_read_b128 v[204:207], v250 offset:3072
    ds_read_b128 v[208:211], v250 offset:4096
    ds_read_b128 v[240:243], v251
    ds_read_b128 v[224:227], v251 offset:256
    v_mul_f32 v160, v160, v246
    v_mul_f32 v161, v161, v246
    v_mul_f32 v162, v162, v246
    v_mul_f32 v163, v163, v246
    v_mul_f32 v164, v164, v246
    v_mul_f32 v165, v165, v246
    v_mul_f32 v166, v166, v246
    v_mul_f32 v167, v167, v246
    v_cvt_pk_bf16_f32 v160, v160, v161
    v_cvt_pk_bf16_f32 v161, v162, v163
    v_cvt_pk_bf16_f32 v162, v164, v165
    v_cvt_pk_bf16_f32 v163, v166, v167
    ds_write_b128 v248, v[160:163]
    s_waitcnt lgkmcnt(7)
    v_mfma_f32_16x16x32_bf16 v[128:131], v[0:3], v[192:195], 0
    v_mul_f32 v168, v168, v246
    v_mul_f32 v169, v169, v246
    v_mfma_f32_16x16x32_bf16 v[132:135], v[32:35], v[192:195], 0
    v_mul_f32 v170, v170, v246
    v_mfma_f32_16x16x32_bf16 v[136:139], v[64:67], v[192:195], 0
    v_mul_f32 v171, v171, v246
    v_mul_f32 v172, v172, v246
    v_mfma_f32_16x16x32_bf16 v[140:143], v[96:99], v[192:195], 0
    ds_read_b128 v[212:215], v250 offset:5120
    v_mul_f32 v173, v173, v246
    s_waitcnt lgkmcnt(7)
    v_mfma_f32_16x16x32_bf16 v[144:147], v[0:3], v[196:199], 0
    v_mul_f32 v174, v174, v246
    v_mul_f32 v175, v175, v246
    v_mfma_f32_16x16x32_bf16 v[148:151], v[32:35], v[196:199], 0
    v_cvt_pk_bf16_f32 v168, v168, v169
    v_mfma_f32_16x16x32_bf16 v[152:155], v[64:67], v[196:199], 0
    v_cvt_pk_bf16_f32 v169, v170, v171
    v_cvt_pk_bf16_f32 v170, v172, v173
    v_mfma_f32_16x16x32_bf16 v[156:159], v[96:99], v[196:199], 0
    ds_read_b128 v[216:219], v250 offset:6144
    v_cvt_pk_bf16_f32 v171, v174, v175
    s_waitcnt lgkmcnt(7)
    v_mfma_f32_16x16x32_bf16 v[128:131], v[4:7], v[200:203], v[128:131]
    ds_write_b128 v254, v[168:171]
    v_mul_f32 v176, v176, v247
    v_mfma_f32_16x16x32_bf16 v[132:135], v[36:39], v[200:203], v[132:135]
    v_mul_f32 v177, v177, v247
    v_mfma_f32_16x16x32_bf16 v[136:139], v[68:71], v[200:203], v[136:139]
    v_mul_f32 v178, v178, v247
    v_mul_f32 v179, v179, v247
    v_mfma_f32_16x16x32_bf16 v[140:143], v[100:103], v[200:203], v[140:143]
    ds_read_b128 v[220:223], v250 offset:7168
    v_mul_f32 v180, v180, v247
    s_waitcnt lgkmcnt(8)
    v_mfma_f32_16x16x32_bf16 v[144:147], v[4:7], v[204:207], v[144:147]
    v_mul_f32 v181, v181, v247
    v_mul_f32 v182, v182, v247
    v_mfma_f32_16x16x32_bf16 v[148:151], v[36:39], v[204:207], v[148:151]
    v_mul_f32 v183, v183, v247
    v_mfma_f32_16x16x32_bf16 v[152:155], v[68:71], v[204:207], v[152:155]
    v_cvt_pk_bf16_f32 v176, v176, v177
    v_cvt_pk_bf16_f32 v177, v178, v179
    v_mfma_f32_16x16x32_bf16 v[156:159], v[100:103], v[204:207], v[156:159]
    ds_read_b128 v[192:195], v250 offset:8192
    v_cvt_pk_bf16_f32 v178, v180, v181
    s_waitcnt lgkmcnt(8)
    v_mfma_f32_16x16x32_bf16 v[128:131], v[8:11], v[208:211], v[128:131]
    v_cvt_pk_bf16_f32 v179, v182, v183
    ds_write_b128 v248, v[176:179] offset:2048
    v_mfma_f32_16x16x32_bf16 v[132:135], v[40:43], v[208:211], v[132:135]
    v_mul_f32 v184, v184, v247
    v_mfma_f32_16x16x32_bf16 v[136:139], v[72:75], v[208:211], v[136:139]
    v_mul_f32 v185, v185, v247
    v_mul_f32 v186, v186, v247
    v_mfma_f32_16x16x32_bf16 v[140:143], v[104:107], v[208:211], v[140:143]
    ds_read_b128 v[196:199], v250 offset:9216
    v_mul_f32 v187, v187, v247
    s_waitcnt lgkmcnt(6)
    v_mfma_f32_16x16x32_bf16 v[144:147], v[8:11], v[212:215], v[144:147]
    v_mul_f32 v188, v188, v247
    v_mul_f32 v189, v189, v247
    v_mfma_f32_16x16x32_bf16 v[148:151], v[40:43], v[212:215], v[148:151]
    v_mul_f32 v190, v190, v247
    v_mfma_f32_16x16x32_bf16 v[152:155], v[72:75], v[212:215], v[152:155]
    v_mul_f32 v191, v191, v247
    v_cvt_pk_bf16_f32 v184, v184, v185
    v_mfma_f32_16x16x32_bf16 v[156:159], v[104:107], v[212:215], v[156:159]
    ds_read_b128 v[200:203], v250 offset:10240
    v_cvt_pk_bf16_f32 v185, v186, v187
    s_waitcnt lgkmcnt(6)
    v_mfma_f32_16x16x32_bf16 v[128:131], v[12:15], v[216:219], v[128:131]
    v_cvt_pk_bf16_f32 v186, v188, v189
    v_cvt_pk_bf16_f32 v187, v190, v191
    v_mfma_f32_16x16x32_bf16 v[132:135], v[44:47], v[216:219], v[132:135]
    ds_write_b128 v254, v[184:187] offset:2048
    v_mfma_f32_16x16x32_bf16 v[136:139], v[76:79], v[216:219], v[136:139]
    v_add_f32 v240, v240, v241
    v_add_f32 v242, v242, v243
    v_add_f32 v240, v240, v242
    v_rcp_f32 v244, v240
    v_add_f32 v224, v224, v225
    v_add_f32 v226, v226, v227
    v_add_f32 v224, v224, v226
    v_rcp_f32 v245, v224
    v_mfma_f32_16x16x32_bf16 v[140:143], v[108:111], v[216:219], v[140:143]
    ds_read_b128 v[204:207], v250 offset:11264
    s_waitcnt lgkmcnt(6)
    v_mfma_f32_16x16x32_bf16 v[144:147], v[12:15], v[220:223], v[144:147]
    ds_read_b128 v[164:167], v252
    ds_read_b128 v[172:175], v252 offset:1024
    v_mfma_f32_16x16x32_bf16 v[148:151], v[44:47], v[220:223], v[148:151]
    v_mfma_f32_16x16x32_bf16 v[152:155], v[76:79], v[220:223], v[152:155]
    ds_read_b128 v[180:183], v252 offset:2048
    ds_read_b128 v[188:191], v252 offset:3072
    s_mov_b32 s43, s33
    s_add_u32 s33, s33, 16384
    v_mfma_f32_16x16x32_bf16 v[156:159], v[108:111], v[220:223], v[156:159]
    ds_read_b128 v[208:211], v250 offset:12288
    s_waitcnt lgkmcnt(10)
    v_mfma_f32_16x16x32_bf16 v[128:131], v[16:19], v[192:195], v[128:131]
    v_mfma_f32_16x16x32_bf16 v[132:135], v[48:51], v[192:195], v[132:135]
    v_mfma_f32_16x16x32_bf16 v[136:139], v[80:83], v[192:195], v[136:139]
    v_mfma_f32_16x16x32_bf16 v[140:143], v[112:115], v[192:195], v[140:143]
    ds_read_b128 v[212:215], v250 offset:13312
    s_waitcnt lgkmcnt(9)
    v_mfma_f32_16x16x32_bf16 v[144:147], v[16:19], v[196:199], v[144:147]
    s_waitcnt lgkmcnt(5)
    buffer_store_dwordx4 v[164:167], v253, s[12:15], s43 offen nt
    s_add_u32 s43, s43, 4096
    v_mfma_f32_16x16x32_bf16 v[148:151], v[48:51], v[196:199], v[148:151]
    v_mfma_f32_16x16x32_bf16 v[152:155], v[80:83], v[196:199], v[152:155]
    v_mfma_f32_16x16x32_bf16 v[156:159], v[112:115], v[196:199], v[156:159]
    ds_read_b128 v[216:219], v250 offset:14336
    v_mfma_f32_16x16x32_bf16 v[128:131], v[20:23], v[200:203], v[128:131]
    v_mfma_f32_16x16x32_bf16 v[132:135], v[52:55], v[200:203], v[132:135]
    v_mfma_f32_16x16x32_bf16 v[136:139], v[84:87], v[200:203], v[136:139]
    s_waitcnt lgkmcnt(5)
    buffer_store_dwordx4 v[172:175], v253, s[12:15], s43 offen nt
    s_add_u32 s43, s43, 4096
    v_mfma_f32_16x16x32_bf16 v[140:143], v[116:119], v[200:203], v[140:143]
    ds_read_b128 v[220:223], v250 offset:15360
    v_mfma_f32_16x16x32_bf16 v[144:147], v[20:23], v[204:207], v[144:147]
    v_mfma_f32_16x16x32_bf16 v[148:151], v[52:55], v[204:207], v[148:151]
    v_mfma_f32_16x16x32_bf16 v[152:155], v[84:87], v[204:207], v[152:155]
    v_mfma_f32_16x16x32_bf16 v[156:159], v[116:119], v[204:207], v[156:159]
    s_waitcnt lgkmcnt(3)
    v_mfma_f32_16x16x32_bf16 v[128:131], v[24:27], v[208:211], v[128:131]
    buffer_store_dwordx4 v[180:183], v253, s[12:15], s43 offen nt
    s_add_u32 s43, s43, 4096
    v_mfma_f32_16x16x32_bf16 v[132:135], v[56:59], v[208:211], v[132:135]
    v_mfma_f32_16x16x32_bf16 v[136:139], v[88:91], v[208:211], v[136:139]
    v_mfma_f32_16x16x32_bf16 v[140:143], v[120:123], v[208:211], v[140:143]
    s_waitcnt lgkmcnt(2)
    v_mfma_f32_16x16x32_bf16 v[144:147], v[24:27], v[212:215], v[144:147]
    v_mfma_f32_16x16x32_bf16 v[148:151], v[56:59], v[212:215], v[148:151]
    v_mfma_f32_16x16x32_bf16 v[152:155], v[88:91], v[212:215], v[152:155]
    buffer_store_dwordx4 v[188:191], v253, s[12:15], s43 offen nt
    v_mfma_f32_16x16x32_bf16 v[156:159], v[120:123], v[212:215], v[156:159]
    s_waitcnt lgkmcnt(1)
    v_mfma_f32_16x16x32_bf16 v[128:131], v[28:31], v[216:219], v[128:131]
    v_mfma_f32_16x16x32_bf16 v[132:135], v[60:63], v[216:219], v[132:135]
    v_mfma_f32_16x16x32_bf16 v[136:139], v[92:95], v[216:219], v[136:139]
    v_mfma_f32_16x16x32_bf16 v[140:143], v[124:127], v[216:219], v[140:143]
    s_waitcnt lgkmcnt(0)
    v_mfma_f32_16x16x32_bf16 v[144:147], v[28:31], v[220:223], v[144:147]
    v_mfma_f32_16x16x32_bf16 v[148:151], v[60:63], v[220:223], v[148:151]
    v_mfma_f32_16x16x32_bf16 v[152:155], v[92:95], v[220:223], v[152:155]
    v_mfma_f32_16x16x32_bf16 v[156:159], v[124:127], v[220:223], v[156:159]
    s_barrier
    s_add_u32 s34, s34, 1
    ds_read_b128 v[192:195], v250 offset:16384
    ds_read_b128 v[196:199], v250 offset:18432
    ds_read_b128 v[200:203], v250 offset:20480
    ds_read_b128 v[204:207], v250 offset:22528
    ds_read_b128 v[208:211], v250 offset:24576
    ds_read_b128 v[240:243], v251 offset:1024
    ds_read_b128 v[224:227], v251 offset:1280
    v_mul_f32 v128, v128, v244
    v_mul_f32 v129, v129, v244
    v_mul_f32 v130, v130, v244
    v_mul_f32 v131, v131, v244
    v_mul_f32 v132, v132, v244
    v_mul_f32 v133, v133, v244
    v_mul_f32 v134, v134, v244
    v_mul_f32 v135, v135, v244
    v_cvt_pk_bf16_f32 v128, v128, v129
    v_cvt_pk_bf16_f32 v129, v130, v131
    v_cvt_pk_bf16_f32 v130, v132, v133
    v_cvt_pk_bf16_f32 v131, v134, v135
    ds_write_b128 v248, v[128:131]
    s_waitcnt lgkmcnt(7)
    v_mfma_f32_16x16x32_bf16 v[160:163], v[0:3], v[192:195], 0
    v_mfma_f32_16x16x32_bf16 v[164:167], v[32:35], v[192:195], 0
    v_mul_f32 v136, v136, v244
    v_mul_f32 v137, v137, v244
    v_mul_f32 v138, v138, v244
    v_mul_f32 v139, v139, v244
    v_mul_f32 v140, v140, v244
    v_mfma_f32_16x16x32_bf16 v[168:171], v[64:67], v[192:195], 0
    v_mfma_f32_16x16x32_bf16 v[172:175], v[96:99], v[192:195], 0
    ds_read_b128 v[212:215], v250 offset:26624
    v_mul_f32 v141, v141, v244
    v_mul_f32 v142, v142, v244
    v_mul_f32 v143, v143, v244
    v_cvt_pk_bf16_f32 v136, v136, v137
    s_waitcnt lgkmcnt(7)
    v_mfma_f32_16x16x32_bf16 v[160:163], v[4:7], v[196:199], v[160:163]
    v_mfma_f32_16x16x32_bf16 v[164:167], v[36:39], v[196:199], v[164:167]
    v_cvt_pk_bf16_f32 v137, v138, v139
    v_cvt_pk_bf16_f32 v138, v140, v141
    v_cvt_pk_bf16_f32 v139, v142, v143
    ds_write_b128 v254, v[136:139]
    v_mfma_f32_16x16x32_bf16 v[168:171], v[68:71], v[196:199], v[168:171]
    v_mfma_f32_16x16x32_bf16 v[172:175], v[100:103], v[196:199], v[172:175]
    ds_read_b128 v[216:219], v250 offset:28672
    v_mul_f32 v144, v144, v245
    v_mul_f32 v145, v145, v245
    v_mul_f32 v146, v146, v245
    v_mul_f32 v147, v147, v245
    v_mul_f32 v148, v148, v245
    s_waitcnt lgkmcnt(8)
    v_mfma_f32_16x16x32_bf16 v[160:163], v[8:11], v[200:203], v[160:163]
    v_mfma_f32_16x16x32_bf16 v[164:167], v[40:43], v[200:203], v[164:167]
    v_mul_f32 v149, v149, v245
    v_mul_f32 v150, v150, v245
    v_mul_f32 v151, v151, v245
    v_cvt_pk_bf16_f32 v144, v144, v145
    v_mfma_f32_16x16x32_bf16 v[168:171], v[72:75], v[200:203], v[168:171]
    v_mfma_f32_16x16x32_bf16 v[172:175], v[104:107], v[200:203], v[172:175]
    ds_read_b128 v[220:223], v250 offset:30720
    v_cvt_pk_bf16_f32 v145, v146, v147
    v_cvt_pk_bf16_f32 v146, v148, v149
    v_cvt_pk_bf16_f32 v147, v150, v151
    ds_write_b128 v248, v[144:147] offset:2048
    s_waitcnt lgkmcnt(9)
    v_mfma_f32_16x16x32_bf16 v[160:163], v[12:15], v[204:207], v[160:163]
    v_mfma_f32_16x16x32_bf16 v[164:167], v[44:47], v[204:207], v[164:167]
    v_mul_f32 v152, v152, v245
    v_mul_f32 v153, v153, v245
    v_mul_f32 v154, v154, v245
    v_mul_f32 v155, v155, v245
    v_mul_f32 v156, v156, v245
    v_mfma_f32_16x16x32_bf16 v[168:171], v[76:79], v[204:207], v[168:171]
    v_mfma_f32_16x16x32_bf16 v[172:175], v[108:111], v[204:207], v[172:175]
    ds_read_b128 v[192:195], v250 offset:17408
    v_mul_f32 v157, v157, v245
    v_mul_f32 v158, v158, v245
    v_mul_f32 v159, v159, v245
    v_cvt_pk_bf16_f32 v152, v152, v153
    s_waitcnt lgkmcnt(9)
    v_mfma_f32_16x16x32_bf16 v[160:163], v[16:19], v[208:211], v[160:163]
    v_mfma_f32_16x16x32_bf16 v[164:167], v[48:51], v[208:211], v[164:167]
    v_cvt_pk_bf16_f32 v153, v154, v155
    v_cvt_pk_bf16_f32 v154, v156, v157
    v_cvt_pk_bf16_f32 v155, v158, v159
    ds_write_b128 v254, v[152:155] offset:2048
    v_mfma_f32_16x16x32_bf16 v[168:171], v[80:83], v[208:211], v[168:171]
    v_mfma_f32_16x16x32_bf16 v[172:175], v[112:115], v[208:211], v[172:175]
    ds_read_b128 v[196:199], v250 offset:19456
    s_waitcnt lgkmcnt(10)
    v_add_f32 v240, v240, v241
    v_add_f32 v242, v242, v243
    v_add_f32 v240, v240, v242
    v_rcp_f32 v246, v240
    s_waitcnt lgkmcnt(9)
    v_add_f32 v224, v224, v225
    v_add_f32 v226, v226, v227
    v_add_f32 v224, v224, v226
    v_rcp_f32 v247, v224
    s_mov_b32 s43, s33
    s_add_u32 s33, s33, 16384
    s_waitcnt lgkmcnt(7)
    v_mfma_f32_16x16x32_bf16 v[160:163], v[20:23], v[212:215], v[160:163]
    v_mfma_f32_16x16x32_bf16 v[164:167], v[52:55], v[212:215], v[164:167]
    ds_read_b128 v[132:135], v252
    ds_read_b128 v[140:143], v252 offset:1024
    ds_read_b128 v[148:151], v252 offset:2048
    ds_read_b128 v[156:159], v252 offset:3072
    v_mfma_f32_16x16x32_bf16 v[168:171], v[84:87], v[212:215], v[168:171]
    v_mfma_f32_16x16x32_bf16 v[172:175], v[116:119], v[212:215], v[172:175]
    ds_read_b128 v[200:203], v250 offset:21504
    s_waitcnt lgkmcnt(10)
    v_mfma_f32_16x16x32_bf16 v[160:163], v[24:27], v[216:219], v[160:163]
    v_mfma_f32_16x16x32_bf16 v[164:167], v[56:59], v[216:219], v[164:167]
    v_mfma_f32_16x16x32_bf16 v[168:171], v[88:91], v[216:219], v[168:171]
    v_mfma_f32_16x16x32_bf16 v[172:175], v[120:123], v[216:219], v[172:175]
    ds_read_b128 v[204:207], v250 offset:23552
    s_waitcnt lgkmcnt(5)
    buffer_store_dwordx4 v[132:135], v253, s[12:15], s43 offen nt
    s_add_u32 s43, s43, 4096
    v_mfma_f32_16x16x32_bf16 v[160:163], v[28:31], v[220:223], v[160:163]
    v_mfma_f32_16x16x32_bf16 v[164:167], v[60:63], v[220:223], v[164:167]
    v_mfma_f32_16x16x32_bf16 v[168:171], v[92:95], v[220:223], v[168:171]
    v_mfma_f32_16x16x32_bf16 v[172:175], v[124:127], v[220:223], v[172:175]
    ds_read_b128 v[208:211], v250 offset:25600
    s_waitcnt lgkmcnt(5)
    buffer_store_dwordx4 v[140:143], v253, s[12:15], s43 offen nt
    s_add_u32 s43, s43, 4096
    v_mfma_f32_16x16x32_bf16 v[176:179], v[0:3], v[192:195], 0
    v_mfma_f32_16x16x32_bf16 v[180:183], v[32:35], v[192:195], 0
    v_mfma_f32_16x16x32_bf16 v[184:187], v[64:67], v[192:195], 0
    v_mfma_f32_16x16x32_bf16 v[188:191], v[96:99], v[192:195], 0
    ds_read_b128 v[212:215], v250 offset:27648
    s_waitcnt lgkmcnt(5)
    buffer_store_dwordx4 v[148:151], v253, s[12:15], s43 offen nt
    s_add_u32 s43, s43, 4096
    v_mfma_f32_16x16x32_bf16 v[176:179], v[4:7], v[196:199], v[176:179]
    v_mfma_f32_16x16x32_bf16 v[180:183], v[36:39], v[196:199], v[180:183]
    v_mfma_f32_16x16x32_bf16 v[184:187], v[68:71], v[196:199], v[184:187]
    v_mfma_f32_16x16x32_bf16 v[188:191], v[100:103], v[196:199], v[188:191]
    ds_read_b128 v[216:219], v250 offset:29696
    s_waitcnt lgkmcnt(5)
    buffer_store_dwordx4 v[156:159], v253, s[12:15], s43 offen nt
    s_waitcnt lgkmcnt(4)
    v_mfma_f32_16x16x32_bf16 v[176:179], v[8:11], v[200:203], v[176:179]
    v_mfma_f32_16x16x32_bf16 v[180:183], v[40:43], v[200:203], v[180:183]
    v_mfma_f32_16x16x32_bf16 v[184:187], v[72:75], v[200:203], v[184:187]
    v_mfma_f32_16x16x32_bf16 v[188:191], v[104:107], v[200:203], v[188:191]
    ds_read_b128 v[220:223], v250 offset:31744
    v_mul_f32 v160, v160, v246
    v_mul_f32 v161, v161, v246
    v_mul_f32 v162, v162, v246
    s_waitcnt lgkmcnt(4)
    v_mfma_f32_16x16x32_bf16 v[176:179], v[12:15], v[204:207], v[176:179]
    v_mfma_f32_16x16x32_bf16 v[180:183], v[44:47], v[204:207], v[180:183]
    v_mul_f32 v163, v163, v246
    v_mul_f32 v164, v164, v246
    v_mul_f32 v165, v165, v246
    v_mfma_f32_16x16x32_bf16 v[184:187], v[76:79], v[204:207], v[184:187]
    v_mfma_f32_16x16x32_bf16 v[188:191], v[108:111], v[204:207], v[188:191]
    v_mul_f32 v166, v166, v246
    v_mul_f32 v167, v167, v246
    s_waitcnt lgkmcnt(3)
    v_mfma_f32_16x16x32_bf16 v[176:179], v[16:19], v[208:211], v[176:179]
    v_mfma_f32_16x16x32_bf16 v[180:183], v[48:51], v[208:211], v[180:183]
    v_cvt_pk_bf16_f32 v160, v160, v161
    v_cvt_pk_bf16_f32 v161, v162, v163
    v_cvt_pk_bf16_f32 v162, v164, v165
    v_mfma_f32_16x16x32_bf16 v[184:187], v[80:83], v[208:211], v[184:187]
    v_mfma_f32_16x16x32_bf16 v[188:191], v[112:115], v[208:211], v[188:191]
    v_cvt_pk_bf16_f32 v163, v166, v167
    ds_write_b128 v248, v[160:163]
    s_waitcnt lgkmcnt(3)
    v_mfma_f32_16x16x32_bf16 v[176:179], v[20:23], v[212:215], v[176:179]
    v_mfma_f32_16x16x32_bf16 v[180:183], v[52:55], v[212:215], v[180:183]
    v_mul_f32 v168, v168, v246
    v_mul_f32 v169, v169, v246
    v_mul_f32 v170, v170, v246
    v_mfma_f32_16x16x32_bf16 v[184:187], v[84:87], v[212:215], v[184:187]
    v_mfma_f32_16x16x32_bf16 v[188:191], v[116:119], v[212:215], v[188:191]
    v_mul_f32 v171, v171, v246
    v_mul_f32 v172, v172, v246
    v_mul_f32 v173, v173, v246
    s_waitcnt lgkmcnt(2)
    v_mfma_f32_16x16x32_bf16 v[176:179], v[24:27], v[216:219], v[176:179]
    v_mfma_f32_16x16x32_bf16 v[180:183], v[56:59], v[216:219], v[180:183]
    v_mul_f32 v174, v174, v246
    v_mul_f32 v175, v175, v246
    v_mfma_f32_16x16x32_bf16 v[184:187], v[88:91], v[216:219], v[184:187]
    v_mfma_f32_16x16x32_bf16 v[188:191], v[120:123], v[216:219], v[188:191]
    v_cvt_pk_bf16_f32 v168, v168, v169
    v_cvt_pk_bf16_f32 v169, v170, v171
    v_cvt_pk_bf16_f32 v170, v172, v173
    s_waitcnt lgkmcnt(1)
    v_mfma_f32_16x16x32_bf16 v[176:179], v[28:31], v[220:223], v[176:179]
    v_mfma_f32_16x16x32_bf16 v[180:183], v[60:63], v[220:223], v[180:183]
    v_cvt_pk_bf16_f32 v171, v174, v175
    ds_write_b128 v254, v[168:171]
    v_mfma_f32_16x16x32_bf16 v[184:187], v[92:95], v[220:223], v[184:187]
    v_mfma_f32_16x16x32_bf16 v[188:191], v[124:127], v[220:223], v[188:191]
    s_nop 2
    v_mul_f32 v176, v176, v247
    v_mul_f32 v177, v177, v247
    v_mul_f32 v178, v178, v247
    v_mul_f32 v179, v179, v247
    v_mul_f32 v180, v180, v247
    v_mul_f32 v181, v181, v247
    v_mul_f32 v182, v182, v247
    v_mul_f32 v183, v183, v247
    v_cvt_pk_bf16_f32 v176, v176, v177
    v_cvt_pk_bf16_f32 v177, v178, v179
    v_cvt_pk_bf16_f32 v178, v180, v181
    v_cvt_pk_bf16_f32 v179, v182, v183
    ds_write_b128 v248, v[176:179] offset:2048
    v_mul_f32 v184, v184, v247
    v_mul_f32 v185, v185, v247
    v_mul_f32 v186, v186, v247
    v_mul_f32 v187, v187, v247
    v_mul_f32 v188, v188, v247
    v_mul_f32 v189, v189, v247
    v_mul_f32 v190, v190, v247
    v_mul_f32 v191, v191, v247
    v_cvt_pk_bf16_f32 v184, v184, v185
    v_cvt_pk_bf16_f32 v185, v186, v187
    v_cvt_pk_bf16_f32 v186, v188, v189
    v_cvt_pk_bf16_f32 v187, v190, v191
    ds_write_b128 v254, v[184:187] offset:2048
    s_mov_b32 s43, s33
    s_add_u32 s33, s33, 16384
    ds_read_b128 v[164:167], v252
    ds_read_b128 v[172:175], v252 offset:1024
    ds_read_b128 v[180:183], v252 offset:2048
    ds_read_b128 v[188:191], v252 offset:3072
    s_waitcnt lgkmcnt(3)
    buffer_store_dwordx4 v[164:167], v253, s[12:15], s43 offen nt
    s_add_u32 s43, s43, 4096
    s_waitcnt lgkmcnt(2)
    buffer_store_dwordx4 v[172:175], v253, s[12:15], s43 offen nt
    s_add_u32 s43, s43, 4096
    s_waitcnt lgkmcnt(1)
    buffer_store_dwordx4 v[180:183], v253, s[12:15], s43 offen nt
    s_add_u32 s43, s43, 4096
    s_waitcnt lgkmcnt(0)
    buffer_store_dwordx4 v[188:191], v253, s[12:15], s43 offen nt
L_end:
    s_endpgm
.section .rodata,"a"
.p2align 6
.amdhsa_kernel standalone__gqa_softmax__near_ridge_kernel
  .amdhsa_next_free_vgpr 256
  .amdhsa_next_free_sgpr 64
  .amdhsa_accum_offset 256
  .amdhsa_group_segment_fixed_size 0
  .amdhsa_kernarg_size 48
  .amdhsa_user_sgpr_count 2
  .amdhsa_user_sgpr_kernarg_segment_ptr 1
  .amdhsa_system_sgpr_workgroup_id_x 1
.end_amdhsa_kernel
```
